```python
import torch

def _softmax(x, axis=-1):
    return torch.softmax(x, dim=axis)
def _gelu(x):
    return torch.nn.functional.gelu(x, approximate="tanh")
def _silu(x):
    return torch.nn.functional.silu(x)
def _sigmoid(x):
    return torch.sigmoid(x)
def _layernorm(x, axis=-1, eps=1e-5):
    m = x.mean(dim=axis, keepdim=True)
    v = x.var(dim=axis, keepdim=True, unbiased=False)
    return (x - m) / torch.sqrt(v + eps)
def _scatter_add(tgt, idx, src, axis=0):
    return tgt.clone().index_add_(axis, idx, src)
def _segment_sum(src, seg, n):
    out = torch.zeros((n,) + src.shape[1:], dtype=src.dtype)
    return out.index_add_(0, seg, src)
def _pad(x, pw):
    flat = tuple(v for pair in reversed(pw) for v in pair)
    return torch.nn.functional.pad(x, flat)

kernel_name = 'gather_scatter__mpnn_edge_mlp__graph'

def setup_inputs():

    _w = (lambda a: (lambda t: t.to(torch.bfloat16) if t.is_floating_point() else t)(torch.as_tensor(a)))
    N, deg, D, De = 12500, 32, 128, max(4, 1)
    E = N * deg
    return {
        "x": _w((lambda *s: torch.randn(*s, dtype=torch.bfloat16) * 0.05)(N, D)),
        "e_attr": _w((lambda *s: torch.randn(*s, dtype=torch.bfloat16) * 0.4)(E, De)),
        "src": _w((lambda lo, hi, *s: torch.randint(lo, hi, s))(0, N, E).to(torch.int64)),
        "dst": _w((lambda lo, hi, *s: torch.randint(lo, hi, s))(0, N, E).to(torch.int64)),
        "w_msg": _w((lambda *s: torch.randn(*s, dtype=torch.bfloat16) * 0.4)(2 * D + De, D)),
        "w_upd": _w((lambda *s: torch.randn(*s, dtype=torch.bfloat16) * 0.05)(2 * D, D)),
    }

def reference(x, e_attr, src, dst, w_msg, w_upd):
    N, D = x.shape
    m_in = torch.concatenate([x[src], x[dst], e_attr], axis=-1)
    msg = _silu(m_in @ w_msg)
    agg = _segment_sum(msg, dst, N)
    return _silu(torch.concatenate([x, agg], axis=-1) @ w_upd)
```

```asm
; @launch kernel=mpnn_part_kernel grid=(256,1,1) block=(1024,1,1) lds=149504
; @launch kernel=gather_scatter__mpnn_edge_mlp__graph_kernel grid=(256,1,1) block=(768,1,1) lds=126208
.amdgcn_target "amdgcn-amd-amdhsa--gfx950"
.text
.globl mpnn_part_kernel
.p2align 8
.type mpnn_part_kernel,@function
mpnn_part_kernel:
    s_cmp_ge_u32 s2, 256
    s_cbranch_scc1 K1_END
    s_load_dwordx4 s[8:11], s[0:1], 16
    s_load_dwordx4 s[4:7], s[0:1], 0
    s_load_dwordx4 s[12:15], s[0:1], 32
    s_load_dwordx2 s[16:17], s[0:1], 64
    v_lshrrev_b32 v40, 6, v0
    s_mul_i32 s3, s2, 391
    v_readfirstlane_b32 s58, v40
    s_getpc_b64 s[60:61]
K1_PC:
    v_lshlrev_b32 v60, 7, v0
    v_min_u32 v60, K2_TEND-K1_PC-4, v60
    s_cmp_ge_u32 s58, 2
    s_cbranch_scc1 K1_NPF
    v_mov_b32 v63, s61
    v_add_co_u32 v62, vcc, s60, v60
    s_nop 1
    v_addc_co_u32 v63, vcc, 0, v63, vcc
    global_load_dword v61, v[62:63], off
K1_NPF:
    s_and_b32 s19, s2, 7
    s_lshl_b32 s19, s19, 5
    s_lshr_b32 s18, s2, 3
    s_add_u32 s19, s19, s18
    v_and_b32 v41, 63, v0
    v_lshlrev_b32 v27, 4, v0
    v_mov_b32 v20, -1
    v_mov_b32 v21, -1
    v_mov_b32 v22, -1
    v_mov_b32 v23, -1
    ds_write_b128 v27, v[20:23] offset:2048
    s_cmp_ge_u32 s58, 8
    s_cbranch_scc1 K1_G
    v_add_u32 v3, s3, v0
    v_lshlrev_b32 v24, 4, v3
    v_lshlrev_b32 v25, 5, v3
    s_mov_b32 s34, 1600000
    s_mov_b32 s35, 0x00020000
    s_mov_b32 s30, 1600000
    s_mov_b32 s31, 0x00020000
    s_mov_b32 s26, 3200000
    s_mov_b32 s27, 0x00020000
    v_cmp_gt_u32 vcc, 391, v0
    s_mov_b32 s18, 100000
    v_cmp_gt_u32 s[56:57], s18, v3
    s_and_b64 s[56:57], s[56:57], vcc
    s_waitcnt lgkmcnt(0)
    s_cbranch_scc0 K1_NOE
    s_mov_b32 s32, s10
    s_mov_b32 s33, s11
    s_mov_b64 exec, s[56:57]
    buffer_load_dwordx4 v[4:7], v24, s[32:35], 0 offen
    s_mov_b32 s28, s8
    s_mov_b32 s29, s9
    buffer_load_dwordx4 v[8:11], v24, s[28:31], 0 offen
    s_mov_b32 s24, s6
    s_mov_b32 s25, s7
    s_mov_b64 exec, -1
K1_NOE:
    s_barrier
    s_mov_b32 s59, 0
K1_SORT:
    s_cmp_lg_u32 s58, 7
    s_cbranch_scc1 K1_S1
    s_mov_b32 s36, s12
    s_mov_b32 s37, s13
    s_mov_b32 s38, 66560
    s_mov_b32 s39, 0x00020000
    s_mov_b32 s40, s14
    s_mov_b32 s41, s15
    s_mov_b32 s42, 65536
    s_mov_b32 s43, 0x00020000
    s_cmp_gt_u32 s2, 64
    s_cbranch_scc1 K1_S1
    s_mov_b32 s59, 1
    s_mov_b32 s60, 1.0
    v_lshlrev_b32 v62, 4, v41
    s_cmp_eq_u32 s2, 64
    s_cbranch_scc1 K1_FW3
    s_lshr_b32 s62, s2, 4
    s_bfe_u32 s63, s2, 0x10003
    s_and_b32 s64, s2, 7
    s_lshl_b32 s61, s62, 13
    s_lshl_b32 s62, s62, 6
    s_lshl_b32 s65, s63, 1
    s_add_u32 s62, s62, s65
    s_lshl_b32 s65, s64, 13
    s_add_u32 s62, s62, s65
    v_and_b32 v60, 15, v41
    v_lshlrev_b32 v60, 2, v60
    v_add_u32 v60, s62, v60
    s_cmp_ge_u32 s64, 4
    s_cbranch_scc1 K1_FWU2
    v_lshrrev_b32 v61, 4, v41
    v_lshl_add_u32 v60, v61, 11, v60
    buffer_load_ushort v64, v60, s[40:43], 0 offen offset:0
    buffer_load_ushort v65, v60, s[40:43], 0 offen offset:256
    buffer_load_ushort v66, v60, s[40:43], 0 offen offset:512
    buffer_load_ushort v67, v60, s[40:43], 0 offen offset:768
    buffer_load_ushort v68, v60, s[40:43], 0 offen offset:1024
    buffer_load_ushort v69, v60, s[40:43], 0 offen offset:1280
    buffer_load_ushort v70, v60, s[40:43], 0 offen offset:1536
    buffer_load_ushort v71, v60, s[40:43], 0 offen offset:1792
    s_lshl_b32 s63, s63, 12
    s_lshl_b32 s64, s64, 10
    s_add_u32 s61, s61, s63
    s_add_u32 s61, s61, s64
    s_add_u32 s61, s61, 6422528
    s_branch K1_S1
K1_FWU2:
    v_lshrrev_b32 v61, 5, v41
    v_lshl_add_u32 v60, v61, 11, v60
    v_lshlrev_b32 v62, 6, v61
    v_bfe_u32 v61, v41, 4, 1
    v_lshl_add_u32 v60, v61, 9, v60
    v_add_u32 v61, 0x1000, v60
    buffer_load_ushort v64, v60, s[40:43], 0 offen offset:0
    buffer_load_ushort v65, v61, s[40:43], 0 offen offset:0
    buffer_load_ushort v66, v60, s[40:43], 0 offen offset:1024
    buffer_load_ushort v67, v61, s[40:43], 0 offen offset:1024
    buffer_load_ushort v68, v60, s[40:43], 0 offen offset:256
    buffer_load_ushort v69, v61, s[40:43], 0 offen offset:256
    buffer_load_ushort v70, v60, s[40:43], 0 offen offset:1280
    buffer_load_ushort v71, v61, s[40:43], 0 offen offset:1280
    v_bfe_u32 v63, v41, 2, 3
    v_lshl_add_u32 v62, v63, 8, v62
    v_and_b32 v63, 3, v41
    v_lshl_add_u32 v62, v63, 4, v62
    s_lshl_b32 s63, s63, 7
    s_lshl_b32 s64, s64, 11
    s_add_u32 s61, s61, s63
    s_add_u32 s61, s61, s64
    s_add_u32 s61, s61, 6447104
    s_branch K1_S1
K1_FW3:
    s_mov_b32 s60, 0xbfb8aa3b
    s_mov_b32 s61, 6488064
    v_bfe_u32 v60, v41, 3, 2
    v_lshlrev_b32 v60, 6, v60
    v_bfe_u32 v61, v41, 2, 1
    v_lshl_add_u32 v60, v61, 4, v60
    v_lshrrev_b32 v61, 5, v41
    v_lshl_add_u32 v60, v61, 3, v60
    v_and_b32 v61, 3, v41
    v_lshl_add_u32 v60, v61, 1, v60
    v_add_u32 v60, 0x10000, v60
    buffer_load_ushort v64, v60, s[36:39], 0 offen offset:0
    buffer_load_ushort v65, v60, s[36:39], 0 offen offset:256
    buffer_load_ushort v66, v60, s[36:39], 0 offen offset:512
    buffer_load_ushort v67, v60, s[36:39], 0 offen offset:768
    buffer_load_ushort v68, v60, s[36:39], 0 offen offset:32
    buffer_load_ushort v69, v60, s[36:39], 0 offen offset:288
    buffer_load_ushort v70, v60, s[36:39], 0 offen offset:544
    buffer_load_ushort v71, v60, s[36:39], 0 offen offset:800
K1_S1:
    s_mov_b32 s44, s16
    s_mov_b32 s45, s17
    s_mov_b32 s46, 20971520
    s_mov_b32 s47, 0x00020000
    v_lshrrev_b32 v42, 3, v0
    v_and_b32 v43, 3, v0
    v_lshlrev_b32 v44, 6, v42
    v_lshl_add_u32 v44, v43, 3, v44
    v_lshlrev_b32 v45, 1, v44
    v_add_u32 v44, 2048, v44
    v_add_u32 v45, 18432, v45
    s_lshl_b32 s62, s19, 6
    v_and_b32 v49, 7, v0
    v_lshlrev_b32 v46, 15, v42
    v_lshl_add_u32 v46, v49, 4, v46
    s_lshl_b32 s63, s19, 7
    v_add_u32 v46, s63, v46
    v_lshrrev_b32 v42, 2, v0
    v_lshlrev_b32 v52, 6, v42
    v_lshl_add_u32 v52, v43, 3, v52
    v_lshlrev_b32 v53, 1, v52
    v_lshlrev_b32 v54, 14, v42
    v_lshl_add_u32 v54, v43, 4, v54
    v_add_u32 v54, s62, v54
    v_mov_b32 v47, 4
    v_mov_b32 v48, 1024
    s_movk_i32 s63, -49
    s_mov_b64 exec, s[56:57]
    s_cbranch_execz K1_SD
    s_mov_b32 s24, s6
    s_mov_b32 s25, s7
    buffer_load_dwordx4 v[12:15], v25, s[24:27], 0 offen
    buffer_load_dwordx4 v[16:19], v25, s[24:27], 0 offen offset:16
    s_waitcnt vmcnt(3)
    v_mul_u32_u24 v20, 21400, v4
    v_mul_u32_u24 v21, 21400, v5
    v_mul_u32_u24 v22, 21400, v6
    v_mul_u32_u24 v23, 21400, v7
    v_lshrrev_b32 v20, 20, v20
    v_lshrrev_b32 v21, 20, v21
    v_lshrrev_b32 v22, 20, v22
    v_lshrrev_b32 v23, 20, v23
    v_lshlrev_b32 v24, 2, v20
    ds_add_rtn_u32 v28, v24, v47 offset:0
    v_lshlrev_b32 v25, 2, v21
    ds_add_rtn_u32 v29, v25, v47 offset:0
    v_lshlrev_b32 v26, 2, v22
    ds_add_rtn_u32 v30, v26, v47 offset:0
    v_lshlrev_b32 v27, 2, v23
    ds_add_rtn_u32 v31, v27, v47 offset:0
    v_mad_i32_i24 v4, v20, s63, v4
    v_mad_i32_i24 v5, v21, s63, v5
    v_mad_i32_i24 v6, v22, s63, v6
    v_mad_i32_i24 v7, v23, s63, v7
    s_waitcnt vmcnt(2)
    v_lshl_add_u32 v4, v8, 6, v4
    v_lshl_add_u32 v5, v9, 6, v5
    v_lshl_add_u32 v6, v10, 6, v6
    v_lshl_add_u32 v7, v11, 6, v7
    v_lshlrev_b32 v4, 2, v4
    v_lshlrev_b32 v5, 2, v5
    v_lshlrev_b32 v6, 2, v6
    v_lshlrev_b32 v7, 2, v7
    s_waitcnt lgkmcnt(3)
    v_lshrrev_b32 v8, 6, v28
    v_cmp_ne_u32 s[64:65], v8, v20
    v_lshlrev_b32 v32, 1, v28
    s_waitcnt lgkmcnt(2)
    v_lshrrev_b32 v9, 6, v29
    v_cmp_ne_u32 s[66:67], v9, v21
    v_lshlrev_b32 v33, 1, v29
    s_waitcnt lgkmcnt(1)
    v_lshrrev_b32 v10, 6, v30
    v_cmp_ne_u32 s[68:69], v10, v22
    v_lshlrev_b32 v34, 1, v30
    s_waitcnt lgkmcnt(0)
    v_lshrrev_b32 v11, 6, v31
    v_cmp_ne_u32 s[52:53], v11, v23
    v_lshlrev_b32 v35, 1, v31
    s_or_b64 s[54:55], s[64:65], s[66:67]
    s_or_b64 vcc, s[68:69], s[52:53]
    s_or_b64 s[54:55], s[54:55], vcc
    s_cbranch_scc1 K1_OVF
    ds_write_b32 v28, v4 offset:2048
    ds_write_b32 v29, v5 offset:2048
    ds_write_b32 v30, v6 offset:2048
    ds_write_b32 v31, v7 offset:2048
    s_waitcnt vmcnt(1)
    ds_write_b64 v32, v[12:13] offset:18432
    ds_write_b64 v33, v[14:15] offset:18432
    s_waitcnt vmcnt(0)
    ds_write_b64 v34, v[16:17] offset:18432
    ds_write_b64 v35, v[18:19] offset:18432
K1_SD:
    s_mov_b64 exec, 1
    s_waitcnt lgkmcnt(0)
    ds_add_u32 v48, v47 offset:4
    s_mov_b64 exec, -1
    s_cmp_eq_u32 s59, 0
    s_cbranch_scc1 K1_POLL
    s_waitcnt vmcnt(0)
    v_lshlrev_b32 v64, 16, v64
    v_lshlrev_b32 v65, 16, v65
    v_lshlrev_b32 v66, 16, v66
    v_lshlrev_b32 v67, 16, v67
    v_lshlrev_b32 v68, 16, v68
    v_lshlrev_b32 v69, 16, v69
    v_lshlrev_b32 v70, 16, v70
    v_lshlrev_b32 v71, 16, v71
    v_mul_f32 v64, s60, v64
    v_mul_f32 v65, s60, v65
    v_mul_f32 v66, s60, v66
    v_mul_f32 v67, s60, v67
    v_mul_f32 v68, s60, v68
    v_mul_f32 v69, s60, v69
    v_mul_f32 v70, s60, v70
    v_mul_f32 v71, s60, v71
    v_cvt_pk_bf16_f32 v12, v64, v65
    v_cvt_pk_bf16_f32 v13, v66, v67
    v_cvt_pk_bf16_f32 v14, v68, v69
    v_cvt_pk_bf16_f32 v15, v70, v71
    v_add_u32 v62, s61, v62
    buffer_store_dwordx4 v[12:15], v62, s[44:47], 0 offen sc1
K1_POLL:
    ds_read_b64 v[50:51], v48
    s_waitcnt lgkmcnt(0)
    v_readfirstlane_b32 s64, v51
    s_cmp_lt_u32 s64, 32
    s_cbranch_scc1 K1_POLL
    ds_read_b64 v[4:5], v52 offset:2048
    ds_read_b64 v[6:7], v52 offset:2080
    ds_read_b64 v[8:9], v52 offset:10240
    ds_read_b64 v[10:11], v52 offset:10272
    ds_read_b128 v[12:15], v53 offset:18432
    ds_read_b128 v[16:19], v53 offset:34816
    s_mov_b32 s64, 8388608
    s_mov_b32 s65, 10485760
    s_mov_b32 s66, 12582912
    s_mov_b32 s67, 14680064
    s_mov_b32 s68, 16777216
    s_mov_b32 s69, 18874368
    s_waitcnt lgkmcnt(4)
    buffer_store_dwordx4 v[4:7], v46, s[44:47], s64 offen sc1
    s_waitcnt lgkmcnt(2)
    buffer_store_dwordx4 v[8:11], v46, s[44:47], s65 offen sc1
    s_waitcnt lgkmcnt(1)
    buffer_store_dwordx4 v[12:15], v54, s[44:47], s66 offen sc1
    s_waitcnt lgkmcnt(0)
    buffer_store_dwordx4 v[16:19], v54, s[44:47], s67 offen sc1
    ds_read_b32 v20, v52 offset:2080
    ds_read_b128 v[24:27], v53 offset:18496
    ds_read_b32 v21, v52 offset:10272
    ds_read_b128 v[28:31], v53 offset:34880
    s_waitcnt lgkmcnt(0)
    v_cmp_le_i32 s[52:53], 0, v20
    v_cmp_le_i32 s[54:55], 0, v21
    s_mov_b64 exec, s[52:53]
    buffer_store_dwordx4 v[24:27], v54, s[44:47], s68 offen sc1
    s_mov_b64 exec, s[54:55]
    buffer_store_dwordx4 v[28:31], v54, s[44:47], s69 offen sc1
    s_mov_b64 exec, -1
    s_cmp_lg_u32 s58, 7
    s_cbranch_scc1 K1_STD
    v_lshlrev_b32 v1, 4, v41
    ds_read_b128 v[32:35], v1 offset:1056
    v_readfirstlane_b32 s64, v50
    s_lshl_b32 s65, s19, 5
    s_add_u32 s65, s65, 6553600
    s_add_u32 s66, s62, 6569952
    s_mov_b32 s67, 0x40000000
    s_waitcnt lgkmcnt(0)
    s_cmp_le_u32 s64, 32
    s_cbranch_scc1 K1_OV1
    v_writelane_b32 v35, s67, 1
K1_OV1:
    s_mov_b64 exec, 3
    buffer_store_dwordx4 v[32:35], v1, s[44:47], s65 offen sc1
    s_mov_b64 exec, 0x3c
    buffer_store_dwordx4 v[32:35], v1, s[44:47], s66 offen sc1
    s_mov_b64 exec, -1
    s_branch K1_STD
K1_G:
    v_and_b32 v1, 0xff, v0
    v_lshlrev_b32 v2, 6, v1
    v_lshlrev_b32 v1, 2, v1
    ds_write_b32 v1, v2 offset:0
    v_cmp_gt_u32 vcc, 8, v41
    v_lshlrev_b32 v1, 2, v41
    s_nop 0
    v_cndmask_b32 v2, -1, 0, vcc
    ds_write_b32 v1, v2 offset:1024
    v_lshlrev_b32 v26, 4, v41
    v_lshrrev_b32 v42, 4, v41
    v_lshlrev_b32 v43, 6, v42
    v_xor_b32 v32, v26, v43
    v_lshlrev_b32 v43, 4, v42
    v_xor_b32 v34, v26, v43
    s_and_b32 s62, s58, 3
    s_lshl_b32 s62, s62, 6
    v_xor_b32 v33, s62, v34
    s_and_b32 s59, s58, 7
    s_lshr_b32 s3, s19, 1
    s_mul_i32 s69, s3, 25088
    s_lshl_b32 s63, s59, 10
    s_add_u32 s62, s69, s63
    s_add_u32 m0, s63, 51200
    s_and_b32 s67, s19, 1
    s_lshl_b32 s64, s67, 15
    s_lshl_b32 s65, s59, 12
    s_add_u32 s64, s64, s65
    s_mov_b32 s22, 3200000
    s_mov_b32 s23, 0x00020000
    s_mov_b32 s38, 66560
    s_mov_b32 s39, 0x00020000
    s_waitcnt lgkmcnt(0)
    s_mov_b32 s20, s4
    s_mov_b32 s21, s5
    s_mov_b32 s36, s12
    s_mov_b32 s37, s13
    buffer_load_dwordx4 v33, s[20:23], s62 offen lds
    s_add_u32 m0, m0, 0x2000
    s_add_u32 s62, s62, 0x2000
    buffer_load_dwordx4 v33, s[20:23], s62 offen lds
    s_add_u32 m0, m0, 0x2000
    s_add_u32 s62, s62, 0x2000
    buffer_load_dwordx4 v33, s[20:23], s62 offen lds
    s_add_u32 m0, m0, 0x2000
    s_add_u32 s62, s62, 0x2000
    s_cmp_lg_u32 s59, 0
    s_cbranch_scc1 K1_GX
    buffer_load_dwordx4 v33, s[20:23], s62 offen lds
K1_GX:
    s_barrier
    s_add_u32 m0, s65, 83968
    s_nop 0
    buffer_load_dwordx4 v32, s[36:39], s64 offen offset:0 lds
    buffer_load_dwordx4 v32, s[36:39], s64 offen offset:1024 lds
    buffer_load_dwordx4 v32, s[36:39], s64 offen offset:2048 lds
    buffer_load_dwordx4 v32, s[36:39], s64 offen offset:3072 lds
    v_mov_b32 v2, 1
    v_mov_b32 v3, 1024
    s_cmp_lt_u32 s59, 4
    s_cbranch_scc1 K1_G4
    s_mov_b64 exec, 1
    s_waitcnt vmcnt(4)
    ds_add_u32 v3, v2 offset:8
    v_mov_b32 v0, 0x10000
    s_waitcnt vmcnt(0)
    ds_add_u32 v3, v0 offset:8
    s_mov_b64 exec, -1
    s_branch K1_STD
K1_G4:
    v_and_b32 v42, 31, v41
    v_lshrrev_b32 v43, 5, v41
    s_lshr_b32 s62, s59, 1
    s_and_b32 s63, s59, 1
    v_and_b32 v44, 15, v41
    v_xor_b32 v44, v44, v43
    v_lshlrev_b32 v44, 4, v44
    v_lshl_add_u32 v44, v42, 8, v44
    s_lshl_b32 s64, s62, 14
    s_add_u32 s66, s64, 51200
    v_add_u32 v4, s66, v44
    v_xor_b32 v5, 32, v4
    v_xor_b32 v6, 64, v4
    v_xor_b32 v7, 96, v4
    v_xor_b32 v8, 128, v4
    v_xor_b32 v9, 160, v4
    v_xor_b32 v10, 192, v4
    v_xor_b32 v11, 224, v4
    v_bfe_u32 v45, v41, 2, 2
    v_lshl_add_u32 v46, v43, 3, v45
    v_lshlrev_b32 v46, 8, v46
    s_lshl_b32 s66, s63, 1
    v_xor_b32 v45, s66, v45
    v_lshl_add_u32 v46, v45, 6, v46
    v_bfe_u32 v45, v41, 4, 1
    v_lshl_add_u32 v46, v45, 5, v46
    v_and_b32 v45, 3, v41
    v_lshl_add_u32 v46, v45, 3, v46
    v_add_u32 v12, 83968, v46
    v_xor_b32 v13, 64, v12
    v_and_b32 v45, 7, v41
    v_lshlrev_b32 v46, 1, v43
    v_xor_b32 v45, v45, v46
    v_lshlrev_b32 v45, 4, v45
    v_lshl_add_u32 v45, v42, 7, v45
    s_lshl_b32 s65, s65, 1
    s_add_u32 s65, s65, 116736
    v_add_u32 v14, s65, v45
    v_lshrrev_b32 v47, 3, v41
    v_lshlrev_b32 v15, 4, v47
    v_xor_b32 v15, v15, v26
    v_add_u32 v15, s65, v15
    s_mul_i32 s68, s67, 3211264
    s_add_u32 s68, s68, s69
    s_mov_b32 s48, s16
    s_mov_b32 s49, s17
    s_add_u32 s50, s68, 25088
    s_mov_b32 s51, 0x00020000
    s_add_u32 s68, s68, s64
    s_lshl_b32 s66, s63, 7
    s_add_u32 s52, s68, s66
    s_add_u32 s53, s52, 4096
    s_add_u32 s54, s52, 8192
    s_add_u32 s55, s52, 12288
    v_lshlrev_b32 v47, 7, v47
    v_add_u32 v1, v47, v26
    s_mov_b32 s64, 0xbfb8aa3b
    s_lshl_b32 s65, s67, 31
    s_xor_b32 s64, s64, s65
    s_mov_b32 s65, s64
    s_cmp_eq_u32 s62, 0
    s_cselect_b32 s56, -1, 3
    s_mov_b32 s57, s56
    v_mov_b32 v2, 0x101
    s_waitcnt vmcnt(0)
    s_mov_b64 exec, 1
    ds_add_u32 v3, v2 offset:8
    s_mov_b64 exec, -1
K1_GP:
    ds_read_b32 v0, v3 offset:8
    s_waitcnt lgkmcnt(0)
    v_readfirstlane_b32 s66, v0
    s_and_b32 s68, s66, 0xffff
    s_cmp_lt_u32 s68, 0x408
    s_cbranch_scc1 K1_GP
    ds_read_b128 v[16:19], v4
    ds_read_b64_tr_b16 v[24:25], v12 offset:0
    ds_read_b64_tr_b16 v[26:27], v12 offset:1024
    ds_read_b64_tr_b16 v[28:29], v13 offset:0
    ds_read_b64_tr_b16 v[30:31], v13 offset:1024
    s_mov_b64 exec, s[56:57]
    ds_read_b128 v[20:23], v4 offset:8192
    s_mov_b64 exec, -1
    ds_read_b128 v[32:35], v5
    ds_read_b64_tr_b16 v[40:41], v12 offset:4096
    ds_read_b64_tr_b16 v[42:43], v12 offset:5120
    ds_read_b64_tr_b16 v[44:45], v13 offset:4096
    ds_read_b64_tr_b16 v[46:47], v13 offset:5120
    s_mov_b64 exec, s[56:57]
    ds_read_b128 v[36:39], v5 offset:8192
    s_mov_b64 exec, -1
    ds_read_b128 v[48:51], v6
    ds_read_b64_tr_b16 v[56:57], v12 offset:8192
    ds_read_b64_tr_b16 v[58:59], v12 offset:9216
    ds_read_b64_tr_b16 v[60:61], v13 offset:8192
    ds_read_b64_tr_b16 v[62:63], v13 offset:9216
    s_mov_b64 exec, s[56:57]
    ds_read_b128 v[52:55], v6 offset:8192
    s_mov_b64 exec, -1
    s_waitcnt lgkmcnt(13)
    v_mfma_f32_32x32x16_bf16 v[64:79], v[24:27], v[16:19], 0
    v_mfma_f32_32x32x16_bf16 v[80:95], v[28:31], v[16:19], 0
    s_waitcnt lgkmcnt(12)
    v_mfma_f32_32x32x16_bf16 v[96:111], v[24:27], v[20:23], 0
    v_mfma_f32_32x32x16_bf16 v[112:127], v[28:31], v[20:23], 0
    ds_read_b128 v[16:19], v7
    ds_read_b64_tr_b16 v[24:25], v12 offset:12288
    ds_read_b64_tr_b16 v[26:27], v12 offset:13312
    ds_read_b64_tr_b16 v[28:29], v13 offset:12288
    ds_read_b64_tr_b16 v[30:31], v13 offset:13312
    s_mov_b64 exec, s[56:57]
    ds_read_b128 v[20:23], v7 offset:8192
    s_mov_b64 exec, -1
    s_waitcnt lgkmcnt(13)
    v_mfma_f32_32x32x16_bf16 v[64:79], v[40:43], v[32:35], v[64:79]
    v_mfma_f32_32x32x16_bf16 v[80:95], v[44:47], v[32:35], v[80:95]
    s_waitcnt lgkmcnt(12)
    v_mfma_f32_32x32x16_bf16 v[96:111], v[40:43], v[36:39], v[96:111]
    v_mfma_f32_32x32x16_bf16 v[112:127], v[44:47], v[36:39], v[112:127]
K1_GQ:
    s_cmp_ge_u32 s66, 0x40408
    s_cbranch_scc1 K1_GR
    ds_read_b32 v0, v3 offset:8
    s_waitcnt lgkmcnt(0)
    v_readfirstlane_b32 s66, v0
    s_branch K1_GQ
K1_GR:
    ds_read_b128 v[32:35], v8
    ds_read_b64_tr_b16 v[40:41], v12 offset:16384
    ds_read_b64_tr_b16 v[42:43], v12 offset:17408
    ds_read_b64_tr_b16 v[44:45], v13 offset:16384
    ds_read_b64_tr_b16 v[46:47], v13 offset:17408
    s_mov_b64 exec, s[56:57]
    ds_read_b128 v[36:39], v8 offset:8192
    s_mov_b64 exec, -1
    s_waitcnt lgkmcnt(13)
    v_mfma_f32_32x32x16_bf16 v[64:79], v[56:59], v[48:51], v[64:79]
    v_mfma_f32_32x32x16_bf16 v[80:95], v[60:63], v[48:51], v[80:95]
    s_waitcnt lgkmcnt(12)
    v_mfma_f32_32x32x16_bf16 v[96:111], v[56:59], v[52:55], v[96:111]
    v_mfma_f32_32x32x16_bf16 v[112:127], v[60:63], v[52:55], v[112:127]
    ds_read_b128 v[48:51], v9
    ds_read_b64_tr_b16 v[56:57], v12 offset:20480
    ds_read_b64_tr_b16 v[58:59], v12 offset:21504
    ds_read_b64_tr_b16 v[60:61], v13 offset:20480
    ds_read_b64_tr_b16 v[62:63], v13 offset:21504
    s_mov_b64 exec, s[56:57]
    ds_read_b128 v[52:55], v9 offset:8192
    s_mov_b64 exec, -1
    s_waitcnt lgkmcnt(13)
    v_mfma_f32_32x32x16_bf16 v[64:79], v[24:27], v[16:19], v[64:79]
    v_mfma_f32_32x32x16_bf16 v[80:95], v[28:31], v[16:19], v[80:95]
    s_waitcnt lgkmcnt(12)
    v_mfma_f32_32x32x16_bf16 v[96:111], v[24:27], v[20:23], v[96:111]
    v_mfma_f32_32x32x16_bf16 v[112:127], v[28:31], v[20:23], v[112:127]
    ds_read_b128 v[16:19], v10
    ds_read_b64_tr_b16 v[24:25], v12 offset:24576
    ds_read_b64_tr_b16 v[26:27], v12 offset:25600
    ds_read_b64_tr_b16 v[28:29], v13 offset:24576
    ds_read_b64_tr_b16 v[30:31], v13 offset:25600
    s_mov_b64 exec, s[56:57]
    ds_read_b128 v[20:23], v10 offset:8192
    s_mov_b64 exec, -1
    s_waitcnt lgkmcnt(13)
    v_mfma_f32_32x32x16_bf16 v[64:79], v[40:43], v[32:35], v[64:79]
    v_mfma_f32_32x32x16_bf16 v[80:95], v[44:47], v[32:35], v[80:95]
    s_waitcnt lgkmcnt(12)
    v_mfma_f32_32x32x16_bf16 v[96:111], v[40:43], v[36:39], v[96:111]
    v_mfma_f32_32x32x16_bf16 v[112:127], v[44:47], v[36:39], v[112:127]
    ds_read_b128 v[32:35], v11
    ds_read_b64_tr_b16 v[40:41], v12 offset:28672
    ds_read_b64_tr_b16 v[42:43], v12 offset:29696
    ds_read_b64_tr_b16 v[44:45], v13 offset:28672
    ds_read_b64_tr_b16 v[46:47], v13 offset:29696
    s_mov_b64 exec, s[56:57]
    ds_read_b128 v[36:39], v11 offset:8192
    s_mov_b64 exec, -1
    s_waitcnt lgkmcnt(13)
    v_mfma_f32_32x32x16_bf16 v[64:79], v[56:59], v[48:51], v[64:79]
    v_mfma_f32_32x32x16_bf16 v[80:95], v[60:63], v[48:51], v[80:95]
    s_waitcnt lgkmcnt(12)
    v_mfma_f32_32x32x16_bf16 v[96:111], v[56:59], v[52:55], v[96:111]
    v_mfma_f32_32x32x16_bf16 v[112:127], v[60:63], v[52:55], v[112:127]
    s_waitcnt lgkmcnt(7)
    v_mfma_f32_32x32x16_bf16 v[64:79], v[24:27], v[16:19], v[64:79]
    v_mfma_f32_32x32x16_bf16 v[80:95], v[28:31], v[16:19], v[80:95]
    s_waitcnt lgkmcnt(6)
    v_mfma_f32_32x32x16_bf16 v[96:111], v[24:27], v[20:23], v[96:111]
    v_mfma_f32_32x32x16_bf16 v[112:127], v[28:31], v[20:23], v[112:127]
    s_waitcnt lgkmcnt(1)
    v_mfma_f32_32x32x16_bf16 v[64:79], v[40:43], v[32:35], v[64:79]
    v_mfma_f32_32x32x16_bf16 v[80:95], v[44:47], v[32:35], v[80:95]
    s_waitcnt lgkmcnt(0)
    v_mfma_f32_32x32x16_bf16 v[96:111], v[40:43], v[36:39], v[96:111]
    v_mfma_f32_32x32x16_bf16 v[112:127], v[44:47], v[36:39], v[112:127]
    v_xor_b32 v4, 16, v14
    v_xor_b32 v5, 64, v14
    v_xor_b32 v6, 0x50, v14
    s_nop 4
    v_pk_mul_f32 v[64:65], v[64:65], s[64:65]
    v_pk_mul_f32 v[66:67], v[66:67], s[64:65]
    v_pk_mul_f32 v[68:69], v[68:69], s[64:65]
    v_pk_mul_f32 v[70:71], v[70:71], s[64:65]
    v_pk_mul_f32 v[72:73], v[72:73], s[64:65]
    v_pk_mul_f32 v[74:75], v[74:75], s[64:65]
    v_pk_mul_f32 v[76:77], v[76:77], s[64:65]
    v_pk_mul_f32 v[78:79], v[78:79], s[64:65]
    v_cvt_pk_bf16_f32 v16, v64, v65
    v_cvt_pk_bf16_f32 v17, v66, v67
    v_cvt_pk_bf16_f32 v18, v68, v69
    v_cvt_pk_bf16_f32 v19, v70, v71
    v_cvt_pk_bf16_f32 v20, v72, v73
    v_cvt_pk_bf16_f32 v21, v74, v75
    v_cvt_pk_bf16_f32 v22, v76, v77
    v_cvt_pk_bf16_f32 v23, v78, v79
    ds_write_b128 v14, v[16:19] offset:0
    ds_write_b128 v4, v[20:23] offset:0
    v_pk_mul_f32 v[80:81], v[80:81], s[64:65]
    v_pk_mul_f32 v[82:83], v[82:83], s[64:65]
    v_pk_mul_f32 v[84:85], v[84:85], s[64:65]
    v_pk_mul_f32 v[86:87], v[86:87], s[64:65]
    v_pk_mul_f32 v[88:89], v[88:89], s[64:65]
    v_pk_mul_f32 v[90:91], v[90:91], s[64:65]
    v_pk_mul_f32 v[92:93], v[92:93], s[64:65]
    v_pk_mul_f32 v[94:95], v[94:95], s[64:65]
    v_cvt_pk_bf16_f32 v24, v80, v81
    v_cvt_pk_bf16_f32 v25, v82, v83
    v_cvt_pk_bf16_f32 v26, v84, v85
    v_cvt_pk_bf16_f32 v27, v86, v87
    v_cvt_pk_bf16_f32 v28, v88, v89
    v_cvt_pk_bf16_f32 v29, v90, v91
    v_cvt_pk_bf16_f32 v30, v92, v93
    v_cvt_pk_bf16_f32 v31, v94, v95
    ds_write_b128 v5, v[24:27] offset:0
    ds_write_b128 v6, v[28:31] offset:0
    ds_read_b128 v[64:67], v15 offset:0
    ds_read_b128 v[68:71], v15 offset:1024
    ds_read_b128 v[72:75], v15 offset:2048
    ds_read_b128 v[76:79], v15 offset:3072
    v_pk_mul_f32 v[96:97], v[96:97], s[64:65]
    v_pk_mul_f32 v[98:99], v[98:99], s[64:65]
    v_pk_mul_f32 v[100:101], v[100:101], s[64:65]
    v_pk_mul_f32 v[102:103], v[102:103], s[64:65]
    v_pk_mul_f32 v[104:105], v[104:105], s[64:65]
    v_pk_mul_f32 v[106:107], v[106:107], s[64:65]
    v_pk_mul_f32 v[108:109], v[108:109], s[64:65]
    v_pk_mul_f32 v[110:111], v[110:111], s[64:65]
    v_cvt_pk_bf16_f32 v32, v96, v97
    v_cvt_pk_bf16_f32 v33, v98, v99
    v_cvt_pk_bf16_f32 v34, v100, v101
    v_cvt_pk_bf16_f32 v35, v102, v103
    v_cvt_pk_bf16_f32 v36, v104, v105
    v_cvt_pk_bf16_f32 v37, v106, v107
    v_cvt_pk_bf16_f32 v38, v108, v109
    v_cvt_pk_bf16_f32 v39, v110, v111
    ds_write_b128 v14, v[32:35] offset:4096
    ds_write_b128 v4, v[36:39] offset:4096
    s_waitcnt lgkmcnt(5)
    buffer_store_dwordx4 v[64:67], v1, s[48:51], s52 offen offset:0 sc1
    s_waitcnt lgkmcnt(4)
    buffer_store_dwordx4 v[68:71], v1, s[48:51], s52 offen offset:2048 sc1
    s_waitcnt lgkmcnt(3)
    buffer_store_dwordx4 v[72:75], v1, s[48:51], s53 offen offset:0 sc1
    s_waitcnt lgkmcnt(2)
    buffer_store_dwordx4 v[76:79], v1, s[48:51], s53 offen offset:2048 sc1
    v_pk_mul_f32 v[112:113], v[112:113], s[64:65]
    v_pk_mul_f32 v[114:115], v[114:115], s[64:65]
    v_pk_mul_f32 v[116:117], v[116:117], s[64:65]
    v_pk_mul_f32 v[118:119], v[118:119], s[64:65]
    v_pk_mul_f32 v[120:121], v[120:121], s[64:65]
    v_pk_mul_f32 v[122:123], v[122:123], s[64:65]
    v_pk_mul_f32 v[124:125], v[124:125], s[64:65]
    v_pk_mul_f32 v[126:127], v[126:127], s[64:65]
    v_cvt_pk_bf16_f32 v40, v112, v113
    v_cvt_pk_bf16_f32 v41, v114, v115
    v_cvt_pk_bf16_f32 v42, v116, v117
    v_cvt_pk_bf16_f32 v43, v118, v119
    v_cvt_pk_bf16_f32 v44, v120, v121
    v_cvt_pk_bf16_f32 v45, v122, v123
    v_cvt_pk_bf16_f32 v46, v124, v125
    v_cvt_pk_bf16_f32 v47, v126, v127
    ds_write_b128 v5, v[40:43] offset:4096
    ds_write_b128 v6, v[44:47] offset:4096
    ds_read_b128 v[80:83], v15 offset:4096
    ds_read_b128 v[84:87], v15 offset:5120
    ds_read_b128 v[88:91], v15 offset:6144
    ds_read_b128 v[92:95], v15 offset:7168
    s_waitcnt lgkmcnt(3)
    buffer_store_dwordx4 v[80:83], v1, s[48:51], s54 offen offset:0 sc1
    s_cmp_eq_u32 s62, 1
    s_cbranch_scc1 K1_STD
    s_waitcnt lgkmcnt(2)
    buffer_store_dwordx4 v[84:87], v1, s[48:51], s54 offen offset:2048 sc1
    s_waitcnt lgkmcnt(1)
    buffer_store_dwordx4 v[88:91], v1, s[48:51], s55 offen offset:0 sc1
    s_waitcnt lgkmcnt(0)
    buffer_store_dwordx4 v[92:95], v1, s[48:51], s55 offen offset:2048 sc1
K1_STD:
K1_END:
    s_endpgm
K1_OVF:
    s_waitcnt vmcnt(0)
    s_andn2_b64 exec, s[56:57], s[64:65]
    ds_write_b32 v28, v4 offset:2048
    ds_write_b64 v32, v[12:13] offset:18432
    s_mov_b64 exec, s[64:65]
    ds_add_rtn_u32 v28, v48, v47
    v_lshl_or_b32 v4, v20, 22, v4
    s_waitcnt lgkmcnt(0)
    v_cmp_gt_u32 vcc, 32, v28
    s_mov_b64 exec, vcc
    v_lshlrev_b32 v32, 1, v28
    ds_write_b32 v28, v4 offset:1056
    ds_write_b64 v32, v[12:13] offset:1088
    s_andn2_b64 exec, s[56:57], s[66:67]
    ds_write_b32 v29, v5 offset:2048
    ds_write_b64 v33, v[14:15] offset:18432
    s_mov_b64 exec, s[66:67]
    ds_add_rtn_u32 v29, v48, v47
    v_lshl_or_b32 v5, v21, 22, v5
    s_waitcnt lgkmcnt(0)
    v_cmp_gt_u32 vcc, 32, v29
    s_mov_b64 exec, vcc
    v_lshlrev_b32 v33, 1, v29
    ds_write_b32 v29, v5 offset:1056
    ds_write_b64 v33, v[14:15] offset:1088
    s_andn2_b64 exec, s[56:57], s[68:69]
    ds_write_b32 v30, v6 offset:2048
    ds_write_b64 v34, v[16:17] offset:18432
    s_mov_b64 exec, s[68:69]
    ds_add_rtn_u32 v30, v48, v47
    v_lshl_or_b32 v6, v22, 22, v6
    s_waitcnt lgkmcnt(0)
    v_cmp_gt_u32 vcc, 32, v30
    s_mov_b64 exec, vcc
    v_lshlrev_b32 v34, 1, v30
    ds_write_b32 v30, v6 offset:1056
    ds_write_b64 v34, v[16:17] offset:1088
    s_andn2_b64 exec, s[56:57], s[52:53]
    ds_write_b32 v31, v7 offset:2048
    ds_write_b64 v35, v[18:19] offset:18432
    s_mov_b64 exec, s[52:53]
    ds_add_rtn_u32 v31, v48, v47
    v_lshl_or_b32 v7, v23, 22, v7
    s_waitcnt lgkmcnt(0)
    v_cmp_gt_u32 vcc, 32, v31
    s_mov_b64 exec, vcc
    v_lshlrev_b32 v35, 1, v31
    ds_write_b32 v31, v7 offset:1056
    ds_write_b64 v35, v[18:19] offset:1088
    s_branch K1_SD
.globl gather_scatter__mpnn_edge_mlp__graph_kernel
.p2align 8
.type gather_scatter__mpnn_edge_mlp__graph_kernel,@function
gather_scatter__mpnn_edge_mlp__graph_kernel:
    s_cmp_ge_u32 s2, 256
    s_cbranch_scc1 K2_END
    s_load_dwordx2 s[8:9], s[0:1], 64
    s_load_dwordx2 s[4:5], s[0:1], 0
    s_load_dwordx2 s[6:7], s[0:1], 48
    v_mov_b32 v147, v0
    v_lshrrev_b32 v1, 6, v0
    s_and_b32 s3, s2, 7
    v_readfirstlane_b32 s44, v1
    s_lshl_b32 s3, s3, 5
    s_lshr_b32 s47, s2, 3
    s_add_u32 s3, s3, s47
    s_mov_b32 s45, 0
    s_mul_i32 s54, s3, 12544
    s_mov_b32 s18, 20971520
    s_mov_b32 s19, 0x00020000
    v_and_b32 v146, 63, v0
K2_PASS:
    s_lshl_b32 s50, s3, 14
    s_and_b32 s48, s3, 1
    s_mul_i32 s48, s48, 64 - 16384
    s_add_u32 s48, s48, s50
    s_add_u32 s48, s48, 8388608
    s_add_u32 s47, s50, 12582912
    s_add_u32 s50, s50, 16777216
    s_add_u32 s49, s48, 0x4000
    v_and_b32 v42, -4, v147
    v_lshlrev_b32 v40, 4, v147
    v_lshlrev_b32 v46, 2, v146
    v_mov_b32 v112, 0
    v_mov_b32 v113, 0
    v_mov_b32 v114, 0
    v_mov_b32 v115, 0
    ds_write_b32 v46, v112 offset:0
    v_add_u32 v41, 0x2000, v40
    v_lshl_add_u32 v42, v42, 4, v40
    s_cmp_ge_u32 s44, 8
    s_cbranch_scc1 K2_PB
    s_waitcnt lgkmcnt(0)
    s_mov_b32 s16, s8
    s_mov_b32 s17, s9
    buffer_load_dwordx4 v[0:3], v42, s[16:19], s48 offen
    buffer_load_dwordx4 v[4:7], v42, s[16:19], s49 offen
    s_barrier
    buffer_load_dwordx4 v[8:11], v40, s[16:19], s47 offen
    buffer_load_dwordx4 v[16:19], v41, s[16:19], s47 offen
    s_branch K2_PC
K2_PB:
    v_lshlrev_b32 v41, 1, v40
    s_mov_b32 s47, 6537216
    s_waitcnt lgkmcnt(0)
    s_mov_b32 s16, s8
    s_mov_b32 s17, s9
    buffer_load_dwordx4 v[0:3], v41, s[16:19], s47 offen
    buffer_load_dwordx4 v[4:7], v41, s[16:19], s47 offen offset:16
    s_barrier
K2_PC:
    v_lshlrev_b32 v45, 4, v146
    s_mov_b32 s47, 6488064
    buffer_load_dwordx4 v[124:127], v45, s[16:19], s47 offen
    ds_write_b128 v40, v[112:115] offset:13856
    ds_write_b128 v40, v[112:115] offset:26144
    v_lshrrev_b32 v46, 4, v147
    s_add_u32 s47, s54, 3211264
    v_lshlrev_b32 v128, 8, v46
    v_add_u32 v128, s47, v128
    v_mov_b32 v129, v128
    v_mov_b32 v130, v128
    v_mov_b32 v131, v128
    v_lshl_add_u32 v46, v46, 4, v40
    ds_write_b128 v46, v[128:131] offset:512
    s_cmp_lt_u32 s44, 8
    s_cbranch_scc1 K2_PD
    ds_write_b128 v40, v[112:115] offset:30240
    v_lshlrev_b32 v46, 2, v146
    s_add_u32 s51, s47, 12288
    v_mov_b32 v47, s51
    ds_write_b32 v46, v47 offset:13568
    v_min_u32 v46, 48, v146
    v_lshlrev_b32 v47, 8, v46
    v_add_u32 v47, s47, v47
    v_mul_u32_u24 v46, 272, v46
    ds_write_b32 v46, v47 offset:768
K2_PD:
    v_and_b32 v96, 31, v146
    v_lshrrev_b32 v97, 5, v146
    v_and_b32 v98, 3, v96
    v_lshlrev_b32 v98, 4, v98
    v_lshl_add_u32 v98, v97, 6, v98
    v_lshrrev_b32 v99, 2, v96
    v_lshl_add_u32 v98, v99, 8, v98
    s_and_b32 s47, s44, 3
    s_lshl_b32 s47, s47, 13
    s_add_u32 s55, s47, 6422528
    s_add_u32 s59, s47, 6426624
    s_add_u32 s47, s47, 6455296
    v_add_u32 v140, s47, v98
    v_add_u32 v141, 2048, v140
    v_add_u32 v142, 4096, v140
    v_add_u32 v143, 6144, v140
    v_and_b32 v99, 1, v99
    v_lshlrev_b32 v148, 7, v99
    v_lshrrev_b32 v99, 3, v96
    v_lshlrev_b32 v149, 2, v99
    v_lshlrev_b32 v98, 3, v97
    v_sub_u32 v98, v96, v98
    v_lshrrev_b32 v98, 1, v98
    v_and_b32 v99, 1, v96
    v_lshlrev_b32 v99, 4, v99
    v_mov_b32 v100, 0x3f80
    v_lshlrev_b32 v99, v99, v100
    v_cmp_eq_u32 vcc, 0, v98
    v_cmp_eq_u32 s[24:25], 8, v98
    s_nop 0
    v_cndmask_b32 v116, 0, v99, vcc
    v_cndmask_b32 v120, 0, v99, s[24:25]
    v_cmp_eq_u32 vcc, 1, v98
    v_cmp_eq_u32 s[24:25], 9, v98
    s_nop 0
    v_cndmask_b32 v117, 0, v99, vcc
    v_cndmask_b32 v121, 0, v99, s[24:25]
    v_cmp_eq_u32 vcc, 2, v98
    v_cmp_eq_u32 s[24:25], 10, v98
    s_nop 0
    v_cndmask_b32 v118, 0, v99, vcc
    v_cndmask_b32 v122, 0, v99, s[24:25]
    v_cmp_eq_u32 vcc, 3, v98
    v_cmp_eq_u32 s[24:25], 11, v98
    s_nop 0
    v_cndmask_b32 v119, 0, v99, vcc
    v_cndmask_b32 v123, 0, v99, s[24:25]
    s_lshl_b32 s47, s44, 2
    v_add_u32 v98, s47, v146
    v_subrev_u32 v99, 49, v98
    v_min_u32 v98, v98, v99
    v_cmp_gt_u32 vcc, 49, v146
    s_nop 1
    v_cndmask_b32 v98, v146, v98, vcc
    v_lshlrev_b32 v150, 2, v98
    v_mul_u32_u24 v151, 272, v98
    s_mov_b32 s40, 0x3465210b
    s_mov_b32 s41, 0x789a
    s_lshr_b64 s[40:41], s[40:41], s47
    s_and_b32 s56, s40, 15
    s_lshl_b32 s56, s56, 4
    s_add_u32 s56, s56, 272
    v_add_u32 v149, s56, v149
    s_mov_b32 s40, 0x11111111
    s_mov_b32 s41, 0x44444444
    s_mov_b32 s42, 0x22222222
    s_mov_b32 s43, 0x88888888
    s_mov_b32 s46, 0
    s_mov_b32 s57, 0
    s_cmp_eq_u32 s44, 0
    s_cselect_b32 s11, 9, 0
    s_mov_b32 s10, 0
    v_mov_b32 v46, 0x10082
    s_mov_b32 s51, 0x400000
    s_cmp_lg_u32 s45, 0
    s_cbranch_scc1 K2_FBI
    s_cmp_ge_u32 s44, 8
    s_cbranch_scc1 K2_OVC
    s_mov_b32 s10, 1
    s_waitcnt vmcnt(4)
    v_cmp_gt_u32 s[24:25], s51, v0
    v_cmp_gt_u32 s[26:27], s51, v1
    v_cmp_gt_u32 s[28:29], s51, v2
    v_cmp_gt_u32 s[30:31], s51, v3
    v_and_b32 v24, 0xfc, v0
    v_and_b32 v25, 0xfc, v1
    v_and_b32 v26, 0xfc, v2
    v_and_b32 v27, 0xfc, v3
    s_mov_b64 exec, s[24:25]
    ds_add_rtn_u32 v32, v24, v46 offset:0
    s_mov_b64 exec, s[26:27]
    ds_add_rtn_u32 v33, v25, v46 offset:0
    s_mov_b64 exec, s[28:29]
    ds_add_rtn_u32 v34, v26, v46 offset:0
    s_mov_b64 exec, s[30:31]
    ds_add_rtn_u32 v35, v27, v46 offset:0
    s_mov_b64 exec, -1
    s_or_b64 exec, s[28:29], 1
    buffer_load_dwordx4 v[12:15], v40, s[16:19], s50 offen
    s_mov_b64 exec, -1
    s_waitcnt vmcnt(4)
    v_cmp_gt_u32 s[32:33], s51, v4
    v_cmp_gt_u32 s[34:35], s51, v5
    v_cmp_gt_u32 s[36:37], s51, v6
    v_cmp_gt_u32 s[38:39], s51, v7
    v_and_b32 v28, 0xfc, v4
    v_and_b32 v29, 0xfc, v5
    v_and_b32 v30, 0xfc, v6
    v_and_b32 v31, 0xfc, v7
    s_mov_b64 exec, s[32:33]
    ds_add_rtn_u32 v36, v28, v46 offset:0
    s_mov_b64 exec, s[34:35]
    ds_add_rtn_u32 v37, v29, v46 offset:0
    s_mov_b64 exec, s[36:37]
    ds_add_rtn_u32 v38, v30, v46 offset:0
    s_mov_b64 exec, s[38:39]
    ds_add_rtn_u32 v39, v31, v46 offset:0
    s_mov_b64 exec, -1
    s_or_b64 exec, s[36:37], 1
    buffer_load_dwordx4 v[20:23], v41, s[16:19], s50 offen
    s_mov_b64 exec, -1
    s_branch K2_B1
K2_OVC:
    s_lshl_b32 s47, s3, 22
    s_waitcnt vmcnt(1)
    v_cmp_eq_u32 vcc, 2.0, v7
    v_xor_b32 v0, s47, v0
    v_xor_b32 v1, s47, v1
    v_xor_b32 v2, s47, v2
    v_xor_b32 v3, s47, v3
    v_xor_b32 v4, s47, v4
    v_xor_b32 v5, s47, v5
    v_xor_b32 v6, s47, v6
    v_xor_b32 v7, s47, v7
    v_min3_u32 v47, v0, v1, v2
    v_min3_u32 v39, v3, v4, v5
    v_min3_u32 v47, v47, v6, v7
    v_min_u32 v47, v47, v39
    v_cmp_gt_u32 s[24:25], s51, v47
    s_or_b64 s[26:27], s[24:25], vcc
    s_cbranch_scc1 K2_OVM
K2_B1:
    s_waitcnt lgkmcnt(0)
    s_barrier
    ds_read_b32 v47, v150 offset:0
    s_cmp_lt_u32 s44, 8
    s_cbranch_scc1 K2_NDMA
    s_cmp_lg_u32 s45, 0
    s_cbranch_scc1 K2_NDMA
    v_and_b32 v44, 0xff, v147
    v_and_b32 v42, 0xfff, v40
    s_lshl_b32 s47, s44, 10
    s_add_u32 s47, s47, 105216
    v_cmp_gt_u32 s[20:21], 16, v44
    s_add_u32 m0, s47, 0
    s_add_u32 s49, s54, 3211264
    buffer_load_dwordx4 v42, s[16:19], s49 offen  lds
    s_add_u32 m0, s47, 4096
    s_add_u32 s49, s54, 3215360
    buffer_load_dwordx4 v42, s[16:19], s49 offen  lds
    s_add_u32 m0, s47, 8192
    s_add_u32 s49, s54, 3219456
    buffer_load_dwordx4 v42, s[16:19], s49 offen  lds
    s_mov_b32 m0, 125696
    s_add_u32 s49, s54, 3223552
    s_mov_b64 exec, s[20:21]
    s_cbranch_execz K2_QX
    buffer_load_dwordx4 v42, s[16:19], s49 offen  lds
K2_QX:
    s_mov_b64 exec, -1
    s_mov_b32 s12, s4
    s_mov_b32 s13, s5
    s_mov_b32 s14, 3200000
    s_mov_b32 s15, 0x00020000
    v_bfe_u32 v42, v147, 4, 4
    v_lshlrev_b32 v43, 4, v42
    v_xor_b32 v43, v43, v40
    v_and_b32 v43, 0xfff, v43
    s_lshl_b32 s47, s44, 10
    s_add_u32 s47, s47, 51968
    v_cmp_gt_u32 s[20:21], 16, v44
    s_add_u32 m0, s47, 0
    s_add_u32 s49, s54, 0
    buffer_load_dwordx4 v43, s[12:15], s49 offen  lds
    s_add_u32 m0, s47, 4096
    s_add_u32 s49, s54, 4096
    buffer_load_dwordx4 v43, s[12:15], s49 offen  lds
    s_add_u32 m0, s47, 8192
    s_add_u32 s49, s54, 8192
    buffer_load_dwordx4 v43, s[12:15], s49 offen  lds
    s_add_u32 m0, s47, 12288
    s_add_u32 s49, s54, 12288
    s_or_b64 exec, s[20:21], 1
    buffer_load_dwordx4 v43, s[12:15], s49 offen  lds
    s_mov_b64 exec, -1
K2_NDMA:
    s_cmp_eq_u32 s10, 0
    s_cbranch_scc1 K2_NOKEY
    s_mov_b32 s47, 68
    v_and_b32 v32, 0xfc, v32
    v_and_b32 v33, 0xfc, v33
    v_and_b32 v34, 0xfc, v34
    v_and_b32 v35, 0xfc, v35
    v_and_b32 v36, 0xfc, v36
    v_and_b32 v37, 0xfc, v37
    v_and_b32 v38, 0xfc, v38
    v_and_b32 v39, 0xfc, v39
    v_mad_u32_u24 v32, v24, s47, v32
    v_mad_u32_u24 v33, v25, s47, v33
    v_mad_u32_u24 v34, v26, s47, v34
    v_mad_u32_u24 v35, v27, s47, v35
    v_mad_u32_u24 v36, v28, s47, v36
    v_mad_u32_u24 v37, v29, s47, v37
    v_mad_u32_u24 v38, v30, s47, v38
    v_mad_u32_u24 v39, v31, s47, v39
    s_waitcnt lgkmcnt(0)
    s_mov_b64 exec, s[24:25]
    ds_write_b32 v32, v0 offset:512
    s_mov_b64 exec, s[26:27]
    ds_write_b32 v33, v1 offset:512
    s_mov_b64 exec, s[28:29]
    ds_write_b32 v34, v2 offset:512
    s_mov_b64 exec, s[30:31]
    ds_write_b32 v35, v3 offset:512
    s_mov_b64 exec, s[32:33]
    ds_write_b32 v36, v4 offset:512
    s_mov_b64 exec, s[34:35]
    ds_write_b32 v37, v5 offset:512
    s_mov_b64 exec, s[36:37]
    ds_write_b32 v38, v6 offset:512
    s_mov_b64 exec, s[38:39]
    ds_write_b32 v39, v7 offset:512
    s_mov_b64 exec, -1
    s_branch K2_RANK
K2_NOKEY:
    s_waitcnt lgkmcnt(0)
K2_RANK:
    s_mov_b32 s47, 0x410000
    v_cmp_le_u32 vcc, s47, v47
    s_mov_b32 s48, 0xffff
    v_min_u32 v47, s51, v47
    v_bfi_b32 v47, s48, v151, v47
    s_cbranch_vccnz K2_OVER
K2_RK2:
    s_mov_b32 exec_hi, 0x1ffff
    v_readlane_b32 s47, v47, 0
    v_readlane_b32 s48, v47, 1
    v_readlane_b32 s49, v47, 2
    v_readlane_b32 s50, v47, 3
    v_readlane_b32 s51, v47, 4
    v_cmp_lt_u32 vcc, s47, v47
    v_cmp_lt_u32 s[20:21], s48, v47
    v_cmp_lt_u32 s[22:23], s49, v47
    v_cmp_lt_u32 s[12:13], s50, v47
    v_cmp_lt_u32 s[14:15], s51, v47
    s_bcnt1_i32_b64 s47, vcc
    s_bcnt1_i32_b64 s48, s[20:21]
    s_bcnt1_i32_b64 s49, s[22:23]
    s_bcnt1_i32_b64 s50, s[12:13]
    s_bcnt1_i32_b64 s51, s[14:15]
    v_writelane_b32 v46, s47, 0
    v_writelane_b32 v46, s48, 1
    v_writelane_b32 v46, s49, 2
    v_writelane_b32 v46, s50, 3
    v_writelane_b32 v46, s51, 4
    s_mov_b64 exec, 31
    v_lshlrev_b32 v46, 2, v46
    ds_write_b32 v46, v47 offset:268
    s_mov_b64 exec, -1
    v_lshlrev_b32 v151, 4, v146
    s_waitcnt lgkmcnt(0)
    s_barrier
    ds_read_b32 v47, v149
    s_setprio 3
    s_mov_b32 s48, 0xff
    v_lshlrev_b32 v32, 1, v32
    v_lshlrev_b32 v33, 1, v33
    v_lshlrev_b32 v34, 1, v34
    v_lshlrev_b32 v35, 1, v35
    v_lshlrev_b32 v36, 1, v36
    v_lshlrev_b32 v37, 1, v37
    v_lshlrev_b32 v38, 1, v38
    v_lshlrev_b32 v39, 1, v39
    s_waitcnt lgkmcnt(0)
    v_and_b32 v46, 0xffff, v47
    v_add_u32 v144, v46, v148
    ds_read_b128 v[40:43], v144 offset:512
    ds_read_b32 v44, v46 offset:768
    ds_read_b128 v[136:139], v144 offset:528
    v_readfirstlane_b32 s58, v47
    v_lshlrev_b32 v145, 1, v144
    s_add_u32 s58, s58, 0x10000
    s_lshr_b32 s58, s58, 17
    s_cmp_eq_u32 s57, 0
    s_cselect_b32 s47, 32, 8
    s_min_u32 s58, s58, s47
    s_mov_b32 s52, s58
    s_waitcnt lgkmcnt(2)
    s_cmp_gt_u32 s58, 0
    s_cselect_b32 s53, s48, -1
    v_bfi_b32 v40, s53, v140, v40
    buffer_load_dwordx4 v[80:83], v40, s[16:19], 0 offen
    buffer_load_dwordx4 v[84:87], v40, s[16:19], 0 offen offset:128
    s_cmp_gt_u32 s58, 1
    s_cselect_b32 s53, s48, -1
    v_bfi_b32 v41, s53, v141, v41
    buffer_load_dwordx4 v[88:91], v41, s[16:19], 0 offen
    buffer_load_dwordx4 v[92:95], v41, s[16:19], 0 offen offset:128
    s_cmp_gt_u32 s58, 2
    s_cselect_b32 s53, s48, -1
    v_bfi_b32 v42, s53, v142, v42
    s_cmp_gt_u32 s58, 3
    s_cselect_b32 s53, s48, -1
    v_bfi_b32 v43, s53, v143, v43
    s_add_u32 s47, s54, 3097856
    s_waitcnt lgkmcnt(1)
    v_bfi_b32 v44, s48, v140, v44
    v_subrev_u32 v44, s47, v44
    s_cmp_eq_u32 s10, 0
    s_cbranch_scc1 K2_XD
    s_waitcnt vmcnt(6)
    s_cmp_lt_u32 s44, 8
    s_cbranch_scc1 K2_EW
    s_waitcnt vmcnt(4)
K2_EW:
    s_mov_b64 exec, s[24:25]
    ds_write_b64 v32, v[8:9] offset:13856
    s_mov_b64 exec, s[26:27]
    ds_write_b64 v33, v[10:11] offset:13856
    s_mov_b64 exec, s[32:33]
    ds_write_b64 v36, v[16:17] offset:13856
    s_mov_b64 exec, s[34:35]
    ds_write_b64 v37, v[18:19] offset:13856
    s_waitcnt vmcnt(5)
    s_mov_b64 exec, s[28:29]
    ds_write_b64 v34, v[12:13] offset:13856
    s_mov_b64 exec, s[30:31]
    ds_write_b64 v35, v[14:15] offset:13856
    s_waitcnt vmcnt(4)
    s_mov_b64 exec, s[36:37]
    ds_write_b64 v38, v[20:21] offset:13856
    s_mov_b64 exec, s[38:39]
    ds_write_b64 v39, v[22:23] offset:13856
    s_mov_b64 exec, -1
K2_XD:
K2_B2:
    s_waitcnt vmcnt(8) lgkmcnt(0)
    s_barrier
K2_GO:
    s_cmp_eq_u32 s58, 0
    s_cbranch_scc1 K2_EMPTY
    ds_read_b128 v[128:131], v44
    ds_read_b128 v[132:135], v44 offset:128
    s_mov_b64 exec, s[40:41]
    ds_read_b64 v[112:113], v145 offset:13856
    s_mov_b64 exec, s[42:43]
    ds_read_b64 v[114:115], v145 offset:13856
    s_mov_b64 exec, -1
    s_lshr_b32 s24, 0x411, s11
    s_andn2_b32 s24, s24, 1
    s_or_b32 s24, s24, 2
    s_mov_b32 s47, 0x80008000
    v_xor_b32 v32, s47, v116
    v_xor_b32 v33, s47, v117
    v_xor_b32 v34, s47, v118
    v_xor_b32 v35, s47, v119
    v_xor_b32 v36, s47, v120
    v_xor_b32 v37, s47, v121
    v_xor_b32 v38, s47, v122
    v_xor_b32 v39, s47, v123
    v_lshlrev_b32 v44, s44, 1
    v_mov_b32 v45, 252
    s_waitcnt lgkmcnt(2)
    v_mfma_f32_32x32x16_bf16 v[64:79], v[128:131], v[32:35], 0
    v_mfma_f32_32x32x16_bf16 v[64:79], v[132:135], v[36:39], v[64:79]
    s_waitcnt vmcnt(4) lgkmcnt(0)
    s_mov_b64 exec, 1
    ds_or_b32 v45, v44
    s_mov_b64 exec, -1
    v_mfma_f32_32x32x16_bf16 v[0:15], v[112:115], v[124:127], v[64:79]
    s_mov_b64 exec, s[40:41]
    ds_read_b64 v[112:113], v145 offset:13864
    s_mov_b64 exec, s[42:43]
    ds_read_b64 v[114:115], v145 offset:13864
    s_mov_b64 exec, -1
    s_waitcnt vmcnt(2)
    v_mfma_f32_32x32x16_bf16 v[0:15], v[80:83], v[116:119], v[0:15]
    v_mfma_f32_32x32x16_bf16 v[0:15], v[84:87], v[120:123], v[0:15]
    buffer_load_dwordx4 v[96:99], v42, s[16:19], 0 offen
    buffer_load_dwordx4 v[100:103], v42, s[16:19], 0 offen offset:128
    s_nop 3
    s_add_u32 s47, s52, s11
    s_cmp_gt_u32 s47, 10
    s_cbranch_scc1 K2_PI
    s_setprio 2
    s_cmp_gt_u32 s47, 4
    s_cbranch_scc1 K2_PI
    s_setprio 1
    s_cmp_gt_u32 s47, 0
    s_cbranch_scc1 K2_PI
    s_setprio 0
K2_PI:
    s_nop 7
    s_cmp_lg_u32 s46, 0
    s_cbranch_scc1 K2_SAFE_IN
    s_cmp_le_u32 s52, 1
    s_cbranch_scc1 K2F_LASTF
    s_waitcnt lgkmcnt(0)
    v_mfma_f32_32x32x16_bf16 v[48:63], v[112:115], v[124:127], v[64:79]
    s_cmp_gt_u32 s52, 3
    s_cselect_b32 s53, 0xff, -1
    s_sub_u32 s52, s52, 1
    v_exp_f32 v16, v0
    v_exp_f32 v17, v1
    s_mov_b64 exec, s[40:41]
    ds_read_b64 v[112:113], v145 offset:13872
    s_mov_b64 exec, s[42:43]
    ds_read_b64 v[114:115], v145 offset:13872
    s_mov_b64 exec, -1
    v_exp_f32 v18, v2
    v_exp_f32 v19, v3
    s_waitcnt vmcnt(2)
    v_mfma_f32_32x32x16_bf16 v[48:63], v[88:91], v[116:119], v[48:63]
    v_exp_f32 v20, v4
    v_exp_f32 v21, v5
    v_exp_f32 v22, v6
    v_exp_f32 v23, v7
    v_mfma_f32_32x32x16_bf16 v[48:63], v[92:95], v[120:123], v[48:63]
    v_exp_f32 v24, v8
    v_exp_f32 v25, v9
    v_exp_f32 v26, v10
    v_exp_f32 v27, v11
    v_exp_f32 v28, v12
    v_exp_f32 v29, v13
    v_exp_f32 v30, v14
    v_exp_f32 v31, v15
    v_pk_add_f32 v[16:17], v[16:17], 1.0 op_sel_hi:[1,0]
    v_pk_add_f32 v[18:19], v[18:19], 1.0 op_sel_hi:[1,0]
    v_pk_add_f32 v[20:21], v[20:21], 1.0 op_sel_hi:[1,0]
    v_pk_add_f32 v[22:23], v[22:23], 1.0 op_sel_hi:[1,0]
    v_pk_add_f32 v[24:25], v[24:25], 1.0 op_sel_hi:[1,0]
    v_pk_add_f32 v[26:27], v[26:27], 1.0 op_sel_hi:[1,0]
    v_pk_add_f32 v[28:29], v[28:29], 1.0 op_sel_hi:[1,0]
    v_pk_add_f32 v[30:31], v[30:31], 1.0 op_sel_hi:[1,0]
    buffer_load_dwordx4 v[104:107], v43, s[16:19], 0 offen
    buffer_load_dwordx4 v[108:111], v43, s[16:19], 0 offen offset:128
    ds_read_b128 v[136:139], v144 offset:528
K2F_LOOP:
    s_bitcmp1_b32 s24, s52
    s_cbranch_scc1 K2_TH1
K2_TB1:
    s_waitcnt lgkmcnt(1)
    v_mfma_f32_32x32x16_bf16 v[32:47], v[112:115], v[124:127], v[64:79]
    s_cmp_gt_u32 s52, 3
    s_cselect_b32 s53, 0xff, -1
    s_sub_u32 s52, s52, 1
    v_exp_f32 v128, v48
    v_exp_f32 v129, v49
    s_mov_b64 exec, s[40:41]
    ds_read_b64 v[112:113], v145 offset:13880
    s_mov_b64 exec, s[42:43]
    ds_read_b64 v[114:115], v145 offset:13880
    s_mov_b64 exec, -1
    v_exp_f32 v130, v50
    v_exp_f32 v131, v51
    s_waitcnt vmcnt(2)
    v_mfma_f32_32x32x16_bf16 v[32:47], v[96:99], v[116:119], v[32:47]
    v_exp_f32 v132, v52
    v_exp_f32 v133, v53
    v_exp_f32 v134, v54
    v_exp_f32 v135, v55
    v_pk_fma_f32 v[48:49], v[48:49], v[16:17], v[0:1]
    v_pk_fma_f32 v[50:51], v[50:51], v[18:19], v[2:3]
    v_pk_fma_f32 v[52:53], v[52:53], v[20:21], v[4:5]
    v_pk_fma_f32 v[54:55], v[54:55], v[22:23], v[6:7]
    v_pk_fma_f32 v[16:17], v[16:17], v[128:129], v[16:17]
    v_pk_fma_f32 v[18:19], v[18:19], v[130:131], v[18:19]
    v_pk_fma_f32 v[20:21], v[20:21], v[132:133], v[20:21]
    v_pk_fma_f32 v[22:23], v[22:23], v[134:135], v[22:23]
    v_pk_fma_f32 v[0:1], v[0:1], v[128:129], v[48:49]
    v_pk_fma_f32 v[2:3], v[2:3], v[130:131], v[50:51]
    v_pk_fma_f32 v[4:5], v[4:5], v[132:133], v[52:53]
    v_pk_fma_f32 v[6:7], v[6:7], v[134:135], v[54:55]
    v_mfma_f32_32x32x16_bf16 v[32:47], v[100:103], v[120:123], v[32:47]
    v_exp_f32 v128, v56
    v_exp_f32 v129, v57
    v_exp_f32 v130, v58
    v_exp_f32 v131, v59
    v_exp_f32 v132, v60
    v_exp_f32 v133, v61
    v_exp_f32 v134, v62
    v_exp_f32 v135, v63
    v_pk_fma_f32 v[56:57], v[56:57], v[24:25], v[8:9]
    v_pk_fma_f32 v[58:59], v[58:59], v[26:27], v[10:11]
    v_pk_fma_f32 v[60:61], v[60:61], v[28:29], v[12:13]
    v_pk_fma_f32 v[62:63], v[62:63], v[30:31], v[14:15]
    v_pk_fma_f32 v[24:25], v[24:25], v[128:129], v[24:25]
    v_pk_fma_f32 v[26:27], v[26:27], v[130:131], v[26:27]
    v_pk_fma_f32 v[28:29], v[28:29], v[132:133], v[28:29]
    v_pk_fma_f32 v[30:31], v[30:31], v[134:135], v[30:31]
    v_pk_fma_f32 v[8:9], v[8:9], v[128:129], v[56:57]
    v_pk_fma_f32 v[10:11], v[10:11], v[130:131], v[58:59]
    v_pk_fma_f32 v[12:13], v[12:13], v[132:133], v[60:61]
    v_pk_fma_f32 v[14:15], v[14:15], v[134:135], v[62:63]
    s_waitcnt lgkmcnt(2)
    v_bfi_b32 v136, s53, v140, v136
    buffer_load_dwordx4 v[80:83], v136, s[16:19], 0 offen
    buffer_load_dwordx4 v[84:87], v136, s[16:19], 0 offen offset:128
    s_bitcmp1_b32 s24, s52
    s_cbranch_scc1 K2_TH2
K2_TB2:
    s_waitcnt lgkmcnt(0)
    v_mfma_f32_32x32x16_bf16 v[48:63], v[112:115], v[124:127], v[64:79]
    s_cmp_gt_u32 s52, 3
    s_cselect_b32 s53, 0xff, -1
    s_sub_u32 s52, s52, 1
    v_exp_f32 v128, v32
    v_exp_f32 v129, v33
    s_mov_b64 exec, s[40:41]
    ds_read_b64 v[112:113], v145 offset:13888
    s_mov_b64 exec, s[42:43]
    ds_read_b64 v[114:115], v145 offset:13888
    s_mov_b64 exec, -1
    v_exp_f32 v130, v34
    v_exp_f32 v131, v35
    s_waitcnt vmcnt(2)
    v_mfma_f32_32x32x16_bf16 v[48:63], v[104:107], v[116:119], v[48:63]
    v_exp_f32 v132, v36
    v_exp_f32 v133, v37
    v_exp_f32 v134, v38
    v_exp_f32 v135, v39
    v_pk_fma_f32 v[32:33], v[32:33], v[16:17], v[0:1]
    v_pk_fma_f32 v[34:35], v[34:35], v[18:19], v[2:3]
    v_pk_fma_f32 v[36:37], v[36:37], v[20:21], v[4:5]
    v_pk_fma_f32 v[38:39], v[38:39], v[22:23], v[6:7]
    v_pk_fma_f32 v[16:17], v[16:17], v[128:129], v[16:17]
    v_pk_fma_f32 v[18:19], v[18:19], v[130:131], v[18:19]
    v_pk_fma_f32 v[20:21], v[20:21], v[132:133], v[20:21]
    v_pk_fma_f32 v[22:23], v[22:23], v[134:135], v[22:23]
    v_pk_fma_f32 v[0:1], v[0:1], v[128:129], v[32:33]
    v_pk_fma_f32 v[2:3], v[2:3], v[130:131], v[34:35]
    v_pk_fma_f32 v[4:5], v[4:5], v[132:133], v[36:37]
    v_pk_fma_f32 v[6:7], v[6:7], v[134:135], v[38:39]
    v_mfma_f32_32x32x16_bf16 v[48:63], v[108:111], v[120:123], v[48:63]
    v_exp_f32 v128, v40
    v_exp_f32 v129, v41
    v_exp_f32 v130, v42
    v_exp_f32 v131, v43
    v_exp_f32 v132, v44
    v_exp_f32 v133, v45
    v_exp_f32 v134, v46
    v_exp_f32 v135, v47
    v_pk_fma_f32 v[40:41], v[40:41], v[24:25], v[8:9]
    v_pk_fma_f32 v[42:43], v[42:43], v[26:27], v[10:11]
    v_pk_fma_f32 v[44:45], v[44:45], v[28:29], v[12:13]
    v_pk_fma_f32 v[46:47], v[46:47], v[30:31], v[14:15]
    v_pk_fma_f32 v[24:25], v[24:25], v[128:129], v[24:25]
    v_pk_fma_f32 v[26:27], v[26:27], v[130:131], v[26:27]
    v_pk_fma_f32 v[28:29], v[28:29], v[132:133], v[28:29]
    v_pk_fma_f32 v[30:31], v[30:31], v[134:135], v[30:31]
    v_pk_fma_f32 v[8:9], v[8:9], v[128:129], v[40:41]
    v_pk_fma_f32 v[10:11], v[10:11], v[130:131], v[42:43]
    v_pk_fma_f32 v[12:13], v[12:13], v[132:133], v[44:45]
    v_pk_fma_f32 v[14:15], v[14:15], v[134:135], v[46:47]
    v_bfi_b32 v137, s53, v141, v137
    buffer_load_dwordx4 v[88:91], v137, s[16:19], 0 offen
    buffer_load_dwordx4 v[92:95], v137, s[16:19], 0 offen offset:128
    s_bitcmp1_b32 s24, s52
    s_cbranch_scc1 K2_TH3
K2_TB3:
    s_waitcnt lgkmcnt(0)
    v_mfma_f32_32x32x16_bf16 v[32:47], v[112:115], v[124:127], v[64:79]
    s_cmp_gt_u32 s52, 3
    s_cselect_b32 s53, 0xff, -1
    s_sub_u32 s52, s52, 1
    v_exp_f32 v128, v48
    v_exp_f32 v129, v49
    s_mov_b64 exec, s[40:41]
    ds_read_b64 v[112:113], v145 offset:13896
    s_mov_b64 exec, s[42:43]
    ds_read_b64 v[114:115], v145 offset:13896
    s_mov_b64 exec, -1
    v_exp_f32 v130, v50
    v_exp_f32 v131, v51
    s_waitcnt vmcnt(2)
    v_mfma_f32_32x32x16_bf16 v[32:47], v[80:83], v[116:119], v[32:47]
    v_exp_f32 v132, v52
    v_exp_f32 v133, v53
    v_exp_f32 v134, v54
    v_exp_f32 v135, v55
    v_pk_fma_f32 v[48:49], v[48:49], v[16:17], v[0:1]
    v_pk_fma_f32 v[50:51], v[50:51], v[18:19], v[2:3]
    v_pk_fma_f32 v[52:53], v[52:53], v[20:21], v[4:5]
    v_pk_fma_f32 v[54:55], v[54:55], v[22:23], v[6:7]
    v_pk_fma_f32 v[16:17], v[16:17], v[128:129], v[16:17]
    v_pk_fma_f32 v[18:19], v[18:19], v[130:131], v[18:19]
    v_pk_fma_f32 v[20:21], v[20:21], v[132:133], v[20:21]
    v_pk_fma_f32 v[22:23], v[22:23], v[134:135], v[22:23]
    v_pk_fma_f32 v[0:1], v[0:1], v[128:129], v[48:49]
    v_pk_fma_f32 v[2:3], v[2:3], v[130:131], v[50:51]
    v_pk_fma_f32 v[4:5], v[4:5], v[132:133], v[52:53]
    v_pk_fma_f32 v[6:7], v[6:7], v[134:135], v[54:55]
    v_mfma_f32_32x32x16_bf16 v[32:47], v[84:87], v[120:123], v[32:47]
    v_exp_f32 v128, v56
    v_exp_f32 v129, v57
    v_exp_f32 v130, v58
    v_exp_f32 v131, v59
    v_exp_f32 v132, v60
    v_exp_f32 v133, v61
    v_exp_f32 v134, v62
    v_exp_f32 v135, v63
    v_pk_fma_f32 v[56:57], v[56:57], v[24:25], v[8:9]
    v_pk_fma_f32 v[58:59], v[58:59], v[26:27], v[10:11]
    v_pk_fma_f32 v[60:61], v[60:61], v[28:29], v[12:13]
    v_pk_fma_f32 v[62:63], v[62:63], v[30:31], v[14:15]
    v_pk_fma_f32 v[24:25], v[24:25], v[128:129], v[24:25]
    v_pk_fma_f32 v[26:27], v[26:27], v[130:131], v[26:27]
    v_pk_fma_f32 v[28:29], v[28:29], v[132:133], v[28:29]
    v_pk_fma_f32 v[30:31], v[30:31], v[134:135], v[30:31]
    v_pk_fma_f32 v[8:9], v[8:9], v[128:129], v[56:57]
    v_pk_fma_f32 v[10:11], v[10:11], v[130:131], v[58:59]
    v_pk_fma_f32 v[12:13], v[12:13], v[132:133], v[60:61]
    v_pk_fma_f32 v[14:15], v[14:15], v[134:135], v[62:63]
    v_bfi_b32 v138, s53, v142, v138
    buffer_load_dwordx4 v[96:99], v138, s[16:19], 0 offen
    buffer_load_dwordx4 v[100:103], v138, s[16:19], 0 offen offset:128
    s_bitcmp1_b32 s24, s52
    s_cbranch_scc1 K2_TH0
K2_TB0:
    s_waitcnt lgkmcnt(0)
    v_mfma_f32_32x32x16_bf16 v[48:63], v[112:115], v[124:127], v[64:79]
    s_cmp_gt_u32 s52, 3
    s_cselect_b32 s53, 0xff, -1
    s_sub_u32 s52, s52, 1
    v_exp_f32 v128, v32
    v_exp_f32 v129, v33
    s_mov_b64 exec, s[40:41]
    ds_read_b64 v[112:113], v145 offset:13904
    s_mov_b64 exec, s[42:43]
    ds_read_b64 v[114:115], v145 offset:13904
    s_mov_b64 exec, -1
    v_exp_f32 v130, v34
    v_exp_f32 v131, v35
    s_waitcnt vmcnt(2)
    v_mfma_f32_32x32x16_bf16 v[48:63], v[88:91], v[116:119], v[48:63]
    v_exp_f32 v132, v36
    v_exp_f32 v133, v37
    v_exp_f32 v134, v38
    v_exp_f32 v135, v39
    v_pk_fma_f32 v[32:33], v[32:33], v[16:17], v[0:1]
    v_pk_fma_f32 v[34:35], v[34:35], v[18:19], v[2:3]
    v_pk_fma_f32 v[36:37], v[36:37], v[20:21], v[4:5]
    v_pk_fma_f32 v[38:39], v[38:39], v[22:23], v[6:7]
    v_pk_fma_f32 v[16:17], v[16:17], v[128:129], v[16:17]
    v_pk_fma_f32 v[18:19], v[18:19], v[130:131], v[18:19]
    v_pk_fma_f32 v[20:21], v[20:21], v[132:133], v[20:21]
    v_pk_fma_f32 v[22:23], v[22:23], v[134:135], v[22:23]
    v_pk_fma_f32 v[0:1], v[0:1], v[128:129], v[32:33]
    v_pk_fma_f32 v[2:3], v[2:3], v[130:131], v[34:35]
    v_pk_fma_f32 v[4:5], v[4:5], v[132:133], v[36:37]
    v_pk_fma_f32 v[6:7], v[6:7], v[134:135], v[38:39]
    v_mfma_f32_32x32x16_bf16 v[48:63], v[92:95], v[120:123], v[48:63]
    v_exp_f32 v128, v40
    v_exp_f32 v129, v41
    v_exp_f32 v130, v42
    v_exp_f32 v131, v43
    v_exp_f32 v132, v44
    v_exp_f32 v133, v45
    v_exp_f32 v134, v46
    v_exp_f32 v135, v47
    v_pk_fma_f32 v[40:41], v[40:41], v[24:25], v[8:9]
    v_pk_fma_f32 v[42:43], v[42:43], v[26:27], v[10:11]
    v_pk_fma_f32 v[44:45], v[44:45], v[28:29], v[12:13]
    v_pk_fma_f32 v[46:47], v[46:47], v[30:31], v[14:15]
    v_pk_fma_f32 v[24:25], v[24:25], v[128:129], v[24:25]
    v_pk_fma_f32 v[26:27], v[26:27], v[130:131], v[26:27]
    v_pk_fma_f32 v[28:29], v[28:29], v[132:133], v[28:29]
    v_pk_fma_f32 v[30:31], v[30:31], v[134:135], v[30:31]
    v_pk_fma_f32 v[8:9], v[8:9], v[128:129], v[40:41]
    v_pk_fma_f32 v[10:11], v[10:11], v[130:131], v[42:43]
    v_pk_fma_f32 v[12:13], v[12:13], v[132:133], v[44:45]
    v_pk_fma_f32 v[14:15], v[14:15], v[134:135], v[46:47]
    v_bfi_b32 v139, s53, v143, v139
    buffer_load_dwordx4 v[104:107], v139, s[16:19], 0 offen
    buffer_load_dwordx4 v[108:111], v139, s[16:19], 0 offen offset:128
    ds_read_b128 v[136:139], v144 offset:544
    v_add_u32 v144, 16, v144
    v_add_u32 v145, 32, v145
    s_branch K2F_LOOP
K2_TH1:
    s_cmp_le_u32 s52, 1
    s_cbranch_scc1 K2F_LASTU1
    s_add_u32 s47, s52, s11
    s_cmp_gt_u32 s47, 10
    s_cbranch_scc1 K2_TB1
    s_setprio 2
    s_cmp_gt_u32 s47, 4
    s_cbranch_scc1 K2_TB1
    s_setprio 1
    s_cmp_gt_u32 s47, 0
    s_cbranch_scc1 K2_TB1
    s_setprio 0
    s_branch K2_TB1
K2_TH2:
    s_cmp_le_u32 s52, 1
    s_cbranch_scc1 K2F_LASTU2
    s_add_u32 s47, s52, s11
    s_cmp_gt_u32 s47, 10
    s_cbranch_scc1 K2_TB2
    s_setprio 2
    s_cmp_gt_u32 s47, 4
    s_cbranch_scc1 K2_TB2
    s_setprio 1
    s_cmp_gt_u32 s47, 0
    s_cbranch_scc1 K2_TB2
    s_setprio 0
    s_branch K2_TB2
K2_TH3:
    s_cmp_le_u32 s52, 1
    s_cbranch_scc1 K2F_LASTU3
    s_add_u32 s47, s52, s11
    s_cmp_gt_u32 s47, 10
    s_cbranch_scc1 K2_TB3
    s_setprio 2
    s_cmp_gt_u32 s47, 4
    s_cbranch_scc1 K2_TB3
    s_setprio 1
    s_cmp_gt_u32 s47, 0
    s_cbranch_scc1 K2_TB3
    s_setprio 0
    s_branch K2_TB3
K2_TH0:
    s_cmp_le_u32 s52, 1
    s_cbranch_scc1 K2F_LASTU0
    s_add_u32 s47, s52, s11
    s_cmp_gt_u32 s47, 10
    s_cbranch_scc1 K2_TB0
    s_setprio 2
    s_cmp_gt_u32 s47, 4
    s_cbranch_scc1 K2_TB0
    s_setprio 1
    s_cmp_gt_u32 s47, 0
    s_cbranch_scc1 K2_TB0
    s_setprio 0
    s_branch K2_TB0
K2F_LASTF:
    buffer_load_dwordx4 v[104:107], v143, s[16:19], 0 offen
    buffer_load_dwordx4 v[108:111], v143, s[16:19], 0 offen offset:128
    buffer_load_dwordx4 v[80:83], v140, s[16:19], 0 offen
    buffer_load_dwordx4 v[84:87], v140, s[16:19], 0 offen offset:128
    buffer_load_dwordx4 v[152:155], v151, s[16:19], s59 offen offset:0
    buffer_load_dwordx4 v[156:159], v151, s[16:19], s59 offen offset:1024
    buffer_load_dwordx4 v[160:163], v151, s[16:19], s59 offen offset:2048
    buffer_load_dwordx4 v[164:167], v151, s[16:19], s59 offen offset:3072
    buffer_load_dwordx4 v[64:67], v151, s[16:19], s55 offen offset:0
    buffer_load_dwordx4 v[68:71], v151, s[16:19], s55 offen offset:1024
    buffer_load_dwordx4 v[72:75], v151, s[16:19], s55 offen offset:2048
    buffer_load_dwordx4 v[76:79], v151, s[16:19], s55 offen offset:3072
    v_exp_f32 v16, v0
    v_exp_f32 v17, v1
    v_exp_f32 v18, v2
    v_exp_f32 v19, v3
    v_exp_f32 v20, v4
    v_exp_f32 v21, v5
    v_exp_f32 v22, v6
    v_exp_f32 v23, v7
    v_exp_f32 v24, v8
    v_exp_f32 v25, v9
    v_exp_f32 v26, v10
    v_exp_f32 v27, v11
    v_exp_f32 v28, v12
    v_exp_f32 v29, v13
    v_exp_f32 v30, v14
    v_exp_f32 v31, v15
    v_pk_add_f32 v[16:17], v[16:17], 1.0 op_sel_hi:[1,0]
    v_pk_add_f32 v[18:19], v[18:19], 1.0 op_sel_hi:[1,0]
    v_pk_add_f32 v[20:21], v[20:21], 1.0 op_sel_hi:[1,0]
    v_pk_add_f32 v[22:23], v[22:23], 1.0 op_sel_hi:[1,0]
    v_pk_add_f32 v[24:25], v[24:25], 1.0 op_sel_hi:[1,0]
    v_pk_add_f32 v[26:27], v[26:27], 1.0 op_sel_hi:[1,0]
    v_pk_add_f32 v[28:29], v[28:29], 1.0 op_sel_hi:[1,0]
    v_pk_add_f32 v[30:31], v[30:31], 1.0 op_sel_hi:[1,0]
    s_branch K2_FLUSH
K2F_LASTU3:
    buffer_load_dwordx4 v[96:99], v142, s[16:19], 0 offen
    buffer_load_dwordx4 v[100:103], v142, s[16:19], 0 offen offset:128
    buffer_load_dwordx4 v[104:107], v143, s[16:19], 0 offen
    buffer_load_dwordx4 v[108:111], v143, s[16:19], 0 offen offset:128
    s_branch K2F_LAST1
K2F_LASTU1:
    buffer_load_dwordx4 v[80:83], v140, s[16:19], 0 offen
    buffer_load_dwordx4 v[84:87], v140, s[16:19], 0 offen offset:128
    buffer_load_dwordx4 v[88:91], v141, s[16:19], 0 offen
    buffer_load_dwordx4 v[92:95], v141, s[16:19], 0 offen offset:128
K2F_LAST1:
    buffer_load_dwordx4 v[152:155], v151, s[16:19], s59 offen offset:0
    buffer_load_dwordx4 v[156:159], v151, s[16:19], s59 offen offset:1024
    buffer_load_dwordx4 v[160:163], v151, s[16:19], s59 offen offset:2048
    buffer_load_dwordx4 v[164:167], v151, s[16:19], s59 offen offset:3072
    buffer_load_dwordx4 v[64:67], v151, s[16:19], s55 offen offset:0
    buffer_load_dwordx4 v[68:71], v151, s[16:19], s55 offen offset:1024
    buffer_load_dwordx4 v[72:75], v151, s[16:19], s55 offen offset:2048
    buffer_load_dwordx4 v[76:79], v151, s[16:19], s55 offen offset:3072
    v_exp_f32 v128, v48
    v_exp_f32 v129, v49
    v_exp_f32 v130, v50
    v_exp_f32 v131, v51
    v_exp_f32 v132, v52
    v_exp_f32 v133, v53
    v_exp_f32 v134, v54
    v_exp_f32 v135, v55
    v_pk_fma_f32 v[48:49], v[48:49], v[16:17], v[0:1]
    v_pk_fma_f32 v[50:51], v[50:51], v[18:19], v[2:3]
    v_pk_fma_f32 v[52:53], v[52:53], v[20:21], v[4:5]
    v_pk_fma_f32 v[54:55], v[54:55], v[22:23], v[6:7]
    v_pk_fma_f32 v[16:17], v[16:17], v[128:129], v[16:17]
    v_pk_fma_f32 v[18:19], v[18:19], v[130:131], v[18:19]
    v_pk_fma_f32 v[20:21], v[20:21], v[132:133], v[20:21]
    v_pk_fma_f32 v[22:23], v[22:23], v[134:135], v[22:23]
    v_pk_fma_f32 v[0:1], v[0:1], v[128:129], v[48:49]
    v_pk_fma_f32 v[2:3], v[2:3], v[130:131], v[50:51]
    v_pk_fma_f32 v[4:5], v[4:5], v[132:133], v[52:53]
    v_pk_fma_f32 v[6:7], v[6:7], v[134:135], v[54:55]
    v_exp_f32 v128, v56
    v_exp_f32 v129, v57
    v_exp_f32 v130, v58
    v_exp_f32 v131, v59
    v_exp_f32 v132, v60
    v_exp_f32 v133, v61
    v_exp_f32 v134, v62
    v_exp_f32 v135, v63
    v_pk_fma_f32 v[56:57], v[56:57], v[24:25], v[8:9]
    v_pk_fma_f32 v[58:59], v[58:59], v[26:27], v[10:11]
    v_pk_fma_f32 v[60:61], v[60:61], v[28:29], v[12:13]
    v_pk_fma_f32 v[62:63], v[62:63], v[30:31], v[14:15]
    v_pk_fma_f32 v[24:25], v[24:25], v[128:129], v[24:25]
    v_pk_fma_f32 v[26:27], v[26:27], v[130:131], v[26:27]
    v_pk_fma_f32 v[28:29], v[28:29], v[132:133], v[28:29]
    v_pk_fma_f32 v[30:31], v[30:31], v[134:135], v[30:31]
    v_pk_fma_f32 v[8:9], v[8:9], v[128:129], v[56:57]
    v_pk_fma_f32 v[10:11], v[10:11], v[130:131], v[58:59]
    v_pk_fma_f32 v[12:13], v[12:13], v[132:133], v[60:61]
    v_pk_fma_f32 v[14:15], v[14:15], v[134:135], v[62:63]
    s_branch K2_FLUSH
K2F_LASTU2:
    buffer_load_dwordx4 v[88:91], v141, s[16:19], 0 offen
    buffer_load_dwordx4 v[92:95], v141, s[16:19], 0 offen offset:128
    buffer_load_dwordx4 v[96:99], v142, s[16:19], 0 offen
    buffer_load_dwordx4 v[100:103], v142, s[16:19], 0 offen offset:128
    s_branch K2F_LAST0
K2F_LASTU0:
    buffer_load_dwordx4 v[104:107], v143, s[16:19], 0 offen
    buffer_load_dwordx4 v[108:111], v143, s[16:19], 0 offen offset:128
    buffer_load_dwordx4 v[80:83], v140, s[16:19], 0 offen
    buffer_load_dwordx4 v[84:87], v140, s[16:19], 0 offen offset:128
K2F_LAST0:
    buffer_load_dwordx4 v[152:155], v151, s[16:19], s59 offen offset:0
    buffer_load_dwordx4 v[156:159], v151, s[16:19], s59 offen offset:1024
    buffer_load_dwordx4 v[160:163], v151, s[16:19], s59 offen offset:2048
    buffer_load_dwordx4 v[164:167], v151, s[16:19], s59 offen offset:3072
    buffer_load_dwordx4 v[64:67], v151, s[16:19], s55 offen offset:0
    buffer_load_dwordx4 v[68:71], v151, s[16:19], s55 offen offset:1024
    buffer_load_dwordx4 v[72:75], v151, s[16:19], s55 offen offset:2048
    buffer_load_dwordx4 v[76:79], v151, s[16:19], s55 offen offset:3072
    v_exp_f32 v128, v32
    v_exp_f32 v129, v33
    v_exp_f32 v130, v34
    v_exp_f32 v131, v35
    v_exp_f32 v132, v36
    v_exp_f32 v133, v37
    v_exp_f32 v134, v38
    v_exp_f32 v135, v39
    v_pk_fma_f32 v[32:33], v[32:33], v[16:17], v[0:1]
    v_pk_fma_f32 v[34:35], v[34:35], v[18:19], v[2:3]
    v_pk_fma_f32 v[36:37], v[36:37], v[20:21], v[4:5]
    v_pk_fma_f32 v[38:39], v[38:39], v[22:23], v[6:7]
    v_pk_fma_f32 v[16:17], v[16:17], v[128:129], v[16:17]
    v_pk_fma_f32 v[18:19], v[18:19], v[130:131], v[18:19]
    v_pk_fma_f32 v[20:21], v[20:21], v[132:133], v[20:21]
    v_pk_fma_f32 v[22:23], v[22:23], v[134:135], v[22:23]
    v_pk_fma_f32 v[0:1], v[0:1], v[128:129], v[32:33]
    v_pk_fma_f32 v[2:3], v[2:3], v[130:131], v[34:35]
    v_pk_fma_f32 v[4:5], v[4:5], v[132:133], v[36:37]
    v_pk_fma_f32 v[6:7], v[6:7], v[134:135], v[38:39]
    v_exp_f32 v128, v40
    v_exp_f32 v129, v41
    v_exp_f32 v130, v42
    v_exp_f32 v131, v43
    v_exp_f32 v132, v44
    v_exp_f32 v133, v45
    v_exp_f32 v134, v46
    v_exp_f32 v135, v47
    v_pk_fma_f32 v[40:41], v[40:41], v[24:25], v[8:9]
    v_pk_fma_f32 v[42:43], v[42:43], v[26:27], v[10:11]
    v_pk_fma_f32 v[44:45], v[44:45], v[28:29], v[12:13]
    v_pk_fma_f32 v[46:47], v[46:47], v[30:31], v[14:15]
    v_pk_fma_f32 v[24:25], v[24:25], v[128:129], v[24:25]
    v_pk_fma_f32 v[26:27], v[26:27], v[130:131], v[26:27]
    v_pk_fma_f32 v[28:29], v[28:29], v[132:133], v[28:29]
    v_pk_fma_f32 v[30:31], v[30:31], v[134:135], v[30:31]
    v_pk_fma_f32 v[8:9], v[8:9], v[128:129], v[40:41]
    v_pk_fma_f32 v[10:11], v[10:11], v[130:131], v[42:43]
    v_pk_fma_f32 v[12:13], v[12:13], v[132:133], v[44:45]
    v_pk_fma_f32 v[14:15], v[14:15], v[134:135], v[46:47]
K2_FLUSH:
    s_mov_b32 s47, s11
    s_cmp_gt_u32 s47, 10
    s_cbranch_scc1 K2_PF
    s_setprio 2
    s_cmp_gt_u32 s47, 4
    s_cbranch_scc1 K2_PF
    s_setprio 1
    s_cmp_gt_u32 s47, 0
    s_cbranch_scc1 K2_PF
    s_setprio 0
K2_PF:
    v_lshrrev_b32 v128, 5, v146
    v_lshlrev_b32 v128, 3, v128
    v_add_u32 v129, s56, v128
    ds_read_b64 v[130:131], v129
    v_max3_f32 v132, v16, v17, v18
    v_max3_f32 v132, v132, v19, v20
    v_max3_f32 v132, v132, v21, v22
    v_max3_f32 v132, v132, v23, v24
    v_max3_f32 v132, v132, v25, v26
    v_max3_f32 v132, v132, v27, v28
    v_max3_f32 v132, v132, v29, v30
    v_max_f32 v132, v132, v31
    v_rcp_f32 v16, v16
    v_rcp_f32 v17, v17
    v_rcp_f32 v18, v18
    v_rcp_f32 v19, v19
    v_rcp_f32 v20, v20
    v_rcp_f32 v21, v21
    v_rcp_f32 v22, v22
    v_rcp_f32 v23, v23
    v_rcp_f32 v24, v24
    v_rcp_f32 v25, v25
    v_rcp_f32 v26, v26
    v_rcp_f32 v27, v27
    v_rcp_f32 v28, v28
    v_rcp_f32 v29, v29
    v_rcp_f32 v30, v30
    v_rcp_f32 v31, v31
    s_mov_b32 s47, 0x7b800000
    v_cmp_lt_f32 s[50:51], s47, v132
    v_and_b32 v133, 31, v146
    v_lshlrev_b32 v133, 3, v133
    v_pk_mul_f32 v[0:1], v[0:1], v[16:17]
    v_pk_mul_f32 v[2:3], v[2:3], v[18:19]
    v_pk_mul_f32 v[4:5], v[4:5], v[20:21]
    v_pk_mul_f32 v[6:7], v[6:7], v[22:23]
    v_pk_mul_f32 v[8:9], v[8:9], v[24:25]
    v_pk_mul_f32 v[10:11], v[10:11], v[26:27]
    v_pk_mul_f32 v[12:13], v[12:13], v[28:29]
    v_pk_mul_f32 v[14:15], v[14:15], v[30:31]
    s_mov_b32 s48, 0xbf317218
    s_mov_b32 s49, s48
    s_cmp_lg_u32 s57, 0
    s_cbranch_scc1 K2_FSP
    v_permlane32_swap_b32 v0, v8
    v_permlane32_swap_b32 v1, v9
    v_permlane32_swap_b32 v2, v10
    v_permlane32_swap_b32 v3, v11
    v_permlane32_swap_b32 v4, v12
    v_permlane32_swap_b32 v5, v13
    v_permlane32_swap_b32 v6, v14
    v_permlane32_swap_b32 v7, v15
    v_pk_add_f32 v[0:1], v[0:1], v[8:9]
    v_pk_add_f32 v[2:3], v[2:3], v[10:11]
    v_pk_add_f32 v[4:5], v[4:5], v[12:13]
    v_pk_add_f32 v[6:7], v[6:7], v[14:15]
    v_pk_mul_f32 v[16:17], v[0:1], 0 op_sel_hi:[1,0]
    v_pk_fma_f32 v[16:17], v[2:3], 0, v[16:17] op_sel_hi:[1,0,1]
    v_pk_fma_f32 v[16:17], v[4:5], 0, v[16:17] op_sel_hi:[1,0,1]
    v_pk_fma_f32 v[16:17], v[6:7], 0, v[16:17] op_sel_hi:[1,0,1]
    v_pk_mul_f32 v[0:1], v[0:1], s[48:49]
    v_pk_mul_f32 v[2:3], v[2:3], s[48:49]
    v_pk_mul_f32 v[4:5], v[4:5], s[48:49]
    v_pk_mul_f32 v[6:7], v[6:7], s[48:49]
    v_cmp_u_f32 vcc, v16, v17
    s_waitcnt lgkmcnt(0)
    v_and_b32 v130, 0xffff, v130
    v_and_b32 v131, 0xffff, v131
    v_add_u32 v130, v130, v133
    v_add_u32 v131, v131, v133
    s_or_b64 vcc, vcc, s[50:51]
    s_cbranch_scc1 K2_GUARD
K2_FOK:
    s_cmp_lg_u32 s45, 0
    s_cbranch_scc1 K2_FACC
    v_cvt_pk_bf16_f32 v8, v0, v1
    v_cvt_pk_bf16_f32 v9, v2, v3
    v_cvt_pk_bf16_f32 v10, v4, v5
    v_cvt_pk_bf16_f32 v11, v6, v7
    ds_write_b64 v130, v[8:9] offset:42528
    ds_write_b64 v131, v[10:11] offset:42528
K2_FD:
    s_cmp_eq_u32 s44, 0
    s_cbranch_scc1 K2_TOSP
K2_B4:
    v_mov_b32 v45, 252
K2_XP:
    ds_read_b32 v44, v45
    s_waitcnt lgkmcnt(0)
    v_readfirstlane_b32 s47, v44
    s_cmp_lt_u32 s47, 0xf00
    s_cbranch_scc1 K2_XP
    s_and_b32 s47, s44, 3
    s_lshr_b32 s48, s44, 2
    v_and_b32 v44, 15, v146
    v_lshrrev_b32 v45, 4, v146
    v_mul_u32_u24 v46, 272, v44
    v_lshl_add_u32 v46, v45, 4, v46
    s_mul_i32 s49, s48, 4352
    v_add_u32 v46, s49, v46
    v_xor_b32 v47, v44, v45
    v_lshl_add_u32 v47, v44, 4, v47
    v_lshlrev_b32 v47, 4, v47
    s_lshl_b32 s49, s48, 12
    s_add_u32 s49, s49, 60160
    v_add_u32 v47, s49, v47
    v_xor_b32 v49, 64, v47
    v_xor_b32 v50, 128, v47
    v_xor_b32 v51, 192, v47
    ds_read_b128 v[0:3], v47
    ds_read_b128 v[4:7], v49
    ds_read_b128 v[8:11], v50
    ds_read_b128 v[12:15], v51
    s_cmp_lg_u32 s48, 0
    s_cbranch_scc1 K2_X2
    s_mov_b32 exec_lo, 0x10001
    s_mov_b32 exec_hi, 0x10001
    ds_read_b128 v[112:115], v47 offset:12288
    ds_read_b128 v[116:119], v47 offset:12352
    ds_read_b128 v[120:123], v47 offset:12416
    ds_read_b128 v[124:127], v47 offset:12480
    s_mov_b64 exec, -1
    s_waitcnt vmcnt(0) lgkmcnt(0)
    v_mfma_f32_16x16x32_bf16 v[24:27], v[112:115], v[64:67], 0
    v_mfma_f32_16x16x32_bf16 v[28:31], v[112:115], v[152:155], 0
    v_mfma_f32_16x16x32_bf16 v[24:27], v[116:119], v[68:71], v[24:27]
    v_mfma_f32_16x16x32_bf16 v[28:31], v[116:119], v[156:159], v[28:31]
    v_mfma_f32_16x16x32_bf16 v[24:27], v[120:123], v[72:75], v[24:27]
    v_mfma_f32_16x16x32_bf16 v[28:31], v[120:123], v[160:163], v[28:31]
    v_mfma_f32_16x16x32_bf16 v[24:27], v[124:127], v[76:79], v[24:27]
    v_mfma_f32_16x16x32_bf16 v[28:31], v[124:127], v[164:167], v[28:31]
K2_X2:
    s_waitcnt vmcnt(0) lgkmcnt(0)
    v_mfma_f32_16x16x32_bf16 v[16:19], v[0:3], v[64:67], 0
    v_mfma_f32_16x16x32_bf16 v[20:23], v[0:3], v[152:155], 0
    v_mfma_f32_16x16x32_bf16 v[16:19], v[4:7], v[68:71], v[16:19]
    v_mfma_f32_16x16x32_bf16 v[20:23], v[4:7], v[156:159], v[20:23]
    v_mfma_f32_16x16x32_bf16 v[16:19], v[8:11], v[72:75], v[16:19]
    v_mfma_f32_16x16x32_bf16 v[20:23], v[8:11], v[160:163], v[20:23]
    v_mfma_f32_16x16x32_bf16 v[16:19], v[12:15], v[76:79], v[16:19]
    v_mfma_f32_16x16x32_bf16 v[20:23], v[12:15], v[164:167], v[20:23]
    v_lshlrev_b32 v48, 10, v45
    v_lshl_add_u32 v48, v44, 2, v48
    s_lshl_b32 s49, s48, 12
    s_lshl_b32 s47, s47, 6
    s_add_u32 s47, s47, s49
    s_add_u32 s47, s47, s54
    v_add_u32 v48, s47, v48
    s_add_u32 s49, s54, 12544
    s_min_u32 s22, s49, 3200000
    s_mov_b32 s20, s6
    s_mov_b32 s21, s7
    s_mov_b32 s23, 0x00020000
    s_mov_b32 s47, 0xbfb8aa3b
    s_waitcnt lgkmcnt(0)
    s_barrier
    s_cmp_lg_u32 s45, 0
    s_cbranch_scc1 K2_FBN
K2_FIN:
    ds_read_b128 v[0:3], v46 offset:42528
    ds_read_b128 v[4:7], v46 offset:42592
    ds_read_b128 v[8:11], v46 offset:42656
    ds_read_b128 v[12:15], v46 offset:42720
    s_cmp_lg_u32 s48, 0
    s_cbranch_scc1 K2_FN2
    v_add_u32 v49, 13056, v46
    s_mov_b32 exec_lo, 0x10001
    s_mov_b32 exec_hi, 0x10001
    ds_read_b128 v[64:67], v49 offset:42528
    ds_read_b128 v[68:71], v49 offset:42592
    ds_read_b128 v[72:75], v49 offset:42656
    ds_read_b128 v[76:79], v49 offset:42720
    s_mov_b64 exec, -1
    s_waitcnt lgkmcnt(0)
    v_mfma_f32_16x16x32_bf16 v[24:27], v[64:67], v[80:83], v[24:27]
    v_mfma_f32_16x16x32_bf16 v[28:31], v[64:67], v[84:87], v[28:31]
    v_mfma_f32_16x16x32_bf16 v[24:27], v[68:71], v[88:91], v[24:27]
    v_mfma_f32_16x16x32_bf16 v[28:31], v[68:71], v[92:95], v[28:31]
    v_mfma_f32_16x16x32_bf16 v[24:27], v[72:75], v[96:99], v[24:27]
    v_mfma_f32_16x16x32_bf16 v[28:31], v[72:75], v[100:103], v[28:31]
    v_mfma_f32_16x16x32_bf16 v[24:27], v[76:79], v[104:107], v[24:27]
    v_mfma_f32_16x16x32_bf16 v[28:31], v[76:79], v[108:111], v[28:31]
K2_FN2:
    s_waitcnt lgkmcnt(3)
    v_mfma_f32_16x16x32_bf16 v[16:19], v[0:3], v[80:83], v[16:19]
    v_mfma_f32_16x16x32_bf16 v[20:23], v[0:3], v[84:87], v[20:23]
    s_waitcnt lgkmcnt(2)
    v_mfma_f32_16x16x32_bf16 v[16:19], v[4:7], v[88:91], v[16:19]
    v_mfma_f32_16x16x32_bf16 v[20:23], v[4:7], v[92:95], v[20:23]
    s_waitcnt lgkmcnt(1)
    v_mfma_f32_16x16x32_bf16 v[16:19], v[8:11], v[96:99], v[16:19]
    v_mfma_f32_16x16x32_bf16 v[20:23], v[8:11], v[100:103], v[20:23]
    s_waitcnt lgkmcnt(0)
    v_mfma_f32_16x16x32_bf16 v[16:19], v[12:15], v[104:107], v[16:19]
    v_mfma_f32_16x16x32_bf16 v[20:23], v[12:15], v[108:111], v[20:23]
    s_cmp_lg_u32 s48, 0
    s_cbranch_scc1 K2_FN3
    v_mul_f32 v40, s47, v24
    v_mul_f32 v41, s47, v28
    v_exp_f32 v40, v40
    v_exp_f32 v41, v41
    v_add_f32 v40, 1.0, v40
    v_add_f32 v41, 1.0, v41
    v_rcp_f32 v40, v40
    v_rcp_f32 v41, v41
    v_mul_f32 v40, v40, v24
    v_mul_f32 v41, v41, v28
    v_cvt_pk_bf16_f32 v40, v40, v41
    v_add_u32 v49, 0x3000, v48
    s_mov_b64 exec, 0xffff
    buffer_store_dword v40, v49, s[20:23], 0 offen sc1
    s_mov_b64 exec, -1
K2_FN3:
    s_nop 4
    s_mov_b32 s50, s47
    s_mov_b32 s51, s47
    v_pk_mul_f32 v[32:33], v[16:17], s[50:51]
    v_pk_mul_f32 v[34:35], v[18:19], s[50:51]
    v_pk_mul_f32 v[36:37], v[20:21], s[50:51]
    v_pk_mul_f32 v[38:39], v[22:23], s[50:51]
    v_exp_f32 v32, v32
    v_exp_f32 v33, v33
    v_exp_f32 v34, v34
    v_exp_f32 v35, v35
    v_exp_f32 v36, v36
    v_exp_f32 v37, v37
    v_exp_f32 v38, v38
    v_exp_f32 v39, v39
    v_pk_add_f32 v[32:33], v[32:33], 1.0 op_sel_hi:[1,0]
    v_pk_add_f32 v[34:35], v[34:35], 1.0 op_sel_hi:[1,0]
    v_pk_add_f32 v[36:37], v[36:37], 1.0 op_sel_hi:[1,0]
    v_pk_add_f32 v[38:39], v[38:39], 1.0 op_sel_hi:[1,0]
    v_rcp_f32 v32, v32
    v_rcp_f32 v33, v33
    v_rcp_f32 v34, v34
    v_rcp_f32 v35, v35
    v_rcp_f32 v36, v36
    v_rcp_f32 v37, v37
    v_rcp_f32 v38, v38
    v_rcp_f32 v39, v39
    v_pk_mul_f32 v[32:33], v[32:33], v[16:17]
    v_pk_mul_f32 v[34:35], v[34:35], v[18:19]
    v_pk_mul_f32 v[36:37], v[36:37], v[20:21]
    v_pk_mul_f32 v[38:39], v[38:39], v[22:23]
    v_cvt_pk_bf16_f32 v50, v32, v36
    v_cvt_pk_bf16_f32 v51, v33, v37
    v_cvt_pk_bf16_f32 v52, v34, v38
    v_cvt_pk_bf16_f32 v53, v35, v39
    buffer_store_dword v50, v48, s[20:23], 0 offen offset:0 sc1
    buffer_store_dword v51, v48, s[20:23], 0 offen offset:256 sc1
    buffer_store_dword v52, v48, s[20:23], 0 offen offset:512 sc1
    buffer_store_dword v53, v48, s[20:23], 0 offen offset:768 sc1
K2_END:
    s_endpgm
K2_TOSP:
    s_mov_b32 s57, 1
    s_mov_b32 s11, 0
    s_mov_b32 s46, 0
    v_subrev_u32 v149, s56, v149
    v_lshl_add_u32 v148, v149, 3, v148
    s_mov_b32 s56, 264
    v_mov_b32 v149, 268
    s_branch K2_SETUP
K2_FSP:
    v_pk_add_f32 v[0:1], v[0:1], v[8:9]
    v_pk_add_f32 v[2:3], v[2:3], v[10:11]
    v_pk_add_f32 v[4:5], v[4:5], v[12:13]
    v_pk_add_f32 v[6:7], v[6:7], v[14:15]
    v_pk_add_f32 v[0:1], v[0:1], v[4:5]
    v_pk_add_f32 v[2:3], v[2:3], v[6:7]
    s_nop 1
    v_permlane32_swap_b32 v0, v2
    v_permlane32_swap_b32 v1, v3
    v_pk_add_f32 v[0:1], v[0:1], v[2:3]
    v_pk_mul_f32 v[16:17], v[0:1], 0 op_sel_hi:[1,0]
    v_pk_mul_f32 v[0:1], v[0:1], s[48:49]
    v_cmp_u_f32 vcc, v16, v17
    s_waitcnt lgkmcnt(0)
    v_readfirstlane_b32 s47, v131
    v_lshrrev_b32 v128, 1, v128
    s_and_b32 s47, s47, 0xffff
    v_add3_u32 v130, v133, v128, s47
    s_or_b64 vcc, vcc, s[50:51]
    s_cbranch_scc0 K2_FSOK
    s_cmp_eq_u32 s46, 0
    s_cbranch_scc1 K2_REDO
K2_FSOK:
    s_cmp_lg_u32 s45, 0
    s_cbranch_scc1 K2_FSA
    v_cvt_pk_bf16_f32 v8, v0, v1
    ds_write_b32 v130, v8 offset:42528
    s_branch K2_B4
K2_FSA:
    v_lshlrev_b32 v130, 1, v130
    v_add_u32 v130, 76544, v130
    ds_add_f32 v130, v0 offset:0
    ds_add_f32 v130, v1 offset:4
    s_branch K2_B4
K2_FACC:
    v_lshlrev_b32 v130, 1, v130
    v_add_u32 v130, 76544, v130
    ds_add_f32 v130, v0 offset:0
    ds_add_f32 v130, v1 offset:4
    ds_add_f32 v130, v2 offset:8
    ds_add_f32 v130, v3 offset:12
    v_lshlrev_b32 v131, 1, v131
    v_add_u32 v131, 76544, v131
    ds_add_f32 v131, v4 offset:0
    ds_add_f32 v131, v5 offset:4
    ds_add_f32 v131, v6 offset:8
    ds_add_f32 v131, v7 offset:12
    s_branch K2_FD
K2_GUARD:
    s_cmp_lg_u32 s46, 0
    s_cbranch_scc1 K2_FOK
K2_REDO:
    s_mov_b32 s46, 1
    s_branch K2_SETUP
K2_SETUP:
    ds_read_b32 v47, v149
    s_setprio 3
    s_mov_b32 s48, 0xff
    s_waitcnt lgkmcnt(0)
    v_and_b32 v46, 0xffff, v47
    v_add_u32 v144, v46, v148
    ds_read_b128 v[40:43], v144 offset:512
    ds_read_b32 v44, v46 offset:768
    ds_read_b128 v[136:139], v144 offset:528
    v_readfirstlane_b32 s58, v47
    v_lshlrev_b32 v145, 1, v144
    s_add_u32 s58, s58, 0x10000
    s_lshr_b32 s58, s58, 17
    s_cmp_eq_u32 s57, 0
    s_cselect_b32 s47, 32, 8
    s_min_u32 s58, s58, s47
    s_mov_b32 s52, s58
    s_waitcnt lgkmcnt(2)
    s_cmp_gt_u32 s58, 0
    s_cselect_b32 s53, s48, -1
    v_bfi_b32 v40, s53, v140, v40
    buffer_load_dwordx4 v[80:83], v40, s[16:19], 0 offen
    buffer_load_dwordx4 v[84:87], v40, s[16:19], 0 offen offset:128
    s_cmp_gt_u32 s58, 1
    s_cselect_b32 s53, s48, -1
    v_bfi_b32 v41, s53, v141, v41
    buffer_load_dwordx4 v[88:91], v41, s[16:19], 0 offen
    buffer_load_dwordx4 v[92:95], v41, s[16:19], 0 offen offset:128
    s_cmp_gt_u32 s58, 2
    s_cselect_b32 s53, s48, -1
    v_bfi_b32 v42, s53, v142, v42
    s_cmp_gt_u32 s58, 3
    s_cselect_b32 s53, s48, -1
    v_bfi_b32 v43, s53, v143, v43
    s_add_u32 s47, s54, 3097856
    s_waitcnt lgkmcnt(1)
    v_bfi_b32 v44, s48, v140, v44
    v_subrev_u32 v44, s47, v44
    s_waitcnt vmcnt(4)
    s_branch K2_GO
K2_EMPTY:
    buffer_load_dwordx4 v[96:99], v42, s[16:19], 0 offen
    buffer_load_dwordx4 v[100:103], v42, s[16:19], 0 offen offset:128
    buffer_load_dwordx4 v[104:107], v43, s[16:19], 0 offen
    buffer_load_dwordx4 v[108:111], v43, s[16:19], 0 offen offset:128
    v_lshlrev_b32 v44, s44, 1
    v_mov_b32 v45, 252
    s_waitcnt vmcnt(8) lgkmcnt(0)
    ds_or_b32 v45, v44
    buffer_load_dwordx4 v[152:155], v151, s[16:19], s59 offen offset:0
    buffer_load_dwordx4 v[156:159], v151, s[16:19], s59 offen offset:1024
    buffer_load_dwordx4 v[160:163], v151, s[16:19], s59 offen offset:2048
    buffer_load_dwordx4 v[164:167], v151, s[16:19], s59 offen offset:3072
    buffer_load_dwordx4 v[64:67], v151, s[16:19], s55 offen offset:0
    buffer_load_dwordx4 v[68:71], v151, s[16:19], s55 offen offset:1024
    buffer_load_dwordx4 v[72:75], v151, s[16:19], s55 offen offset:2048
    buffer_load_dwordx4 v[76:79], v151, s[16:19], s55 offen offset:3072
    v_mov_b32 v0, 0
    v_mov_b32 v16, 1.0
    v_mov_b32 v1, 0
    v_mov_b32 v17, 1.0
    v_mov_b32 v2, 0
    v_mov_b32 v18, 1.0
    v_mov_b32 v3, 0
    v_mov_b32 v19, 1.0
    v_mov_b32 v4, 0
    v_mov_b32 v20, 1.0
    v_mov_b32 v5, 0
    v_mov_b32 v21, 1.0
    v_mov_b32 v6, 0
    v_mov_b32 v22, 1.0
    v_mov_b32 v7, 0
    v_mov_b32 v23, 1.0
    v_mov_b32 v8, 0
    v_mov_b32 v24, 1.0
    v_mov_b32 v9, 0
    v_mov_b32 v25, 1.0
    v_mov_b32 v10, 0
    v_mov_b32 v26, 1.0
    v_mov_b32 v11, 0
    v_mov_b32 v27, 1.0
    v_mov_b32 v12, 0
    v_mov_b32 v28, 1.0
    v_mov_b32 v13, 0
    v_mov_b32 v29, 1.0
    v_mov_b32 v14, 0
    v_mov_b32 v30, 1.0
    v_mov_b32 v15, 0
    v_mov_b32 v31, 1.0
    s_branch K2_FLUSH
K2_SAFE_IN:
    s_nop 7
    s_cmp_le_u32 s52, 1
    s_cbranch_scc1 K2S_LASTF
    s_waitcnt lgkmcnt(0)
    v_mfma_f32_32x32x16_bf16 v[48:63], v[112:115], v[124:127], v[64:79]
    s_cmp_gt_u32 s52, 3
    s_cselect_b32 s53, 0xff, -1
    s_sub_u32 s52, s52, 1
    v_exp_f32 v128, v0
    v_exp_f32 v129, v1
    s_mov_b64 exec, s[40:41]
    ds_read_b64 v[112:113], v145 offset:13872
    s_mov_b64 exec, s[42:43]
    ds_read_b64 v[114:115], v145 offset:13872
    s_mov_b64 exec, -1
    v_exp_f32 v130, v2
    v_exp_f32 v131, v3
    s_waitcnt vmcnt(2)
    v_mfma_f32_32x32x16_bf16 v[48:63], v[88:91], v[116:119], v[48:63]
    v_exp_f32 v132, v4
    v_exp_f32 v133, v5
    v_exp_f32 v134, v6
    v_exp_f32 v135, v7
    v_add_f32 v128, 1.0, v128
    v_add_f32 v129, 1.0, v129
    v_add_f32 v130, 1.0, v130
    v_add_f32 v131, 1.0, v131
    v_add_f32 v132, 1.0, v132
    v_add_f32 v133, 1.0, v133
    v_add_f32 v134, 1.0, v134
    v_add_f32 v135, 1.0, v135
    v_rcp_f32 v128, v128
    v_rcp_f32 v129, v129
    v_rcp_f32 v130, v130
    v_rcp_f32 v131, v131
    v_rcp_f32 v132, v132
    v_rcp_f32 v133, v133
    v_rcp_f32 v134, v134
    v_rcp_f32 v135, v135
    v_mul_f32 v0, v0, v128
    v_mul_f32 v1, v1, v129
    v_mul_f32 v2, v2, v130
    v_mul_f32 v3, v3, v131
    v_mul_f32 v4, v4, v132
    v_mul_f32 v5, v5, v133
    v_mul_f32 v6, v6, v134
    v_mul_f32 v7, v7, v135
    v_mov_b32 v16, 1.0
    v_mov_b32 v17, 1.0
    v_mov_b32 v18, 1.0
    v_mov_b32 v19, 1.0
    v_mov_b32 v20, 1.0
    v_mov_b32 v21, 1.0
    v_mov_b32 v22, 1.0
    v_mov_b32 v23, 1.0
    v_mfma_f32_32x32x16_bf16 v[48:63], v[92:95], v[120:123], v[48:63]
    v_exp_f32 v128, v8
    v_exp_f32 v129, v9
    v_exp_f32 v130, v10
    v_exp_f32 v131, v11
    buffer_load_dwordx4 v[104:107], v43, s[16:19], 0 offen
    buffer_load_dwordx4 v[108:111], v43, s[16:19], 0 offen offset:128
    ds_read_b128 v[136:139], v144 offset:528
    v_exp_f32 v132, v12
    v_exp_f32 v133, v13
    v_exp_f32 v134, v14
    v_exp_f32 v135, v15
    v_add_f32 v128, 1.0, v128
    v_add_f32 v129, 1.0, v129
    v_add_f32 v130, 1.0, v130
    v_add_f32 v131, 1.0, v131
    v_add_f32 v132, 1.0, v132
    v_add_f32 v133, 1.0, v133
    v_add_f32 v134, 1.0, v134
    v_add_f32 v135, 1.0, v135
    v_rcp_f32 v128, v128
    v_rcp_f32 v129, v129
    v_rcp_f32 v130, v130
    v_rcp_f32 v131, v131
    v_rcp_f32 v132, v132
    v_rcp_f32 v133, v133
    v_rcp_f32 v134, v134
    v_rcp_f32 v135, v135
    v_mul_f32 v8, v8, v128
    v_mul_f32 v9, v9, v129
    v_mul_f32 v10, v10, v130
    v_mul_f32 v11, v11, v131
    v_mul_f32 v12, v12, v132
    v_mul_f32 v13, v13, v133
    v_mul_f32 v14, v14, v134
    v_mul_f32 v15, v15, v135
    v_mov_b32 v24, 1.0
    v_mov_b32 v25, 1.0
    v_mov_b32 v26, 1.0
    v_mov_b32 v27, 1.0
    v_mov_b32 v28, 1.0
    v_mov_b32 v29, 1.0
    v_mov_b32 v30, 1.0
    v_mov_b32 v31, 1.0
K2S_LOOP:
    s_cmp_le_u32 s52, 1
    s_cbranch_scc1 K2S_LASTU1
    s_waitcnt lgkmcnt(1)
    v_mfma_f32_32x32x16_bf16 v[32:47], v[112:115], v[124:127], v[64:79]
    s_cmp_gt_u32 s52, 3
    s_cselect_b32 s53, 0xff, -1
    s_sub_u32 s52, s52, 1
    v_exp_f32 v128, v48
    v_exp_f32 v129, v49
    s_mov_b64 exec, s[40:41]
    ds_read_b64 v[112:113], v145 offset:13880
    s_mov_b64 exec, s[42:43]
    ds_read_b64 v[114:115], v145 offset:13880
    s_mov_b64 exec, -1
    v_exp_f32 v130, v50
    v_exp_f32 v131, v51
    s_waitcnt vmcnt(2)
    v_mfma_f32_32x32x16_bf16 v[32:47], v[96:99], v[116:119], v[32:47]
    v_exp_f32 v132, v52
    v_exp_f32 v133, v53
    v_exp_f32 v134, v54
    v_exp_f32 v135, v55
    v_add_f32 v128, 1.0, v128
    v_add_f32 v129, 1.0, v129
    v_add_f32 v130, 1.0, v130
    v_add_f32 v131, 1.0, v131
    v_add_f32 v132, 1.0, v132
    v_add_f32 v133, 1.0, v133
    v_add_f32 v134, 1.0, v134
    v_add_f32 v135, 1.0, v135
    v_rcp_f32 v128, v128
    v_rcp_f32 v129, v129
    v_rcp_f32 v130, v130
    v_rcp_f32 v131, v131
    v_rcp_f32 v132, v132
    v_rcp_f32 v133, v133
    v_rcp_f32 v134, v134
    v_rcp_f32 v135, v135
    v_fmac_f32 v0, v48, v128
    v_fmac_f32 v1, v49, v129
    v_fmac_f32 v2, v50, v130
    v_fmac_f32 v3, v51, v131
    v_fmac_f32 v4, v52, v132
    v_fmac_f32 v5, v53, v133
    v_fmac_f32 v6, v54, v134
    v_fmac_f32 v7, v55, v135
    v_mfma_f32_32x32x16_bf16 v[32:47], v[100:103], v[120:123], v[32:47]
    v_exp_f32 v128, v56
    v_exp_f32 v129, v57
    v_exp_f32 v130, v58
    v_exp_f32 v131, v59
    s_waitcnt lgkmcnt(2)
    v_bfi_b32 v136, s53, v140, v136
    buffer_load_dwordx4 v[80:83], v136, s[16:19], 0 offen
    buffer_load_dwordx4 v[84:87], v136, s[16:19], 0 offen offset:128
    v_exp_f32 v132, v60
    v_exp_f32 v133, v61
    v_exp_f32 v134, v62
    v_exp_f32 v135, v63
    v_add_f32 v128, 1.0, v128
    v_add_f32 v129, 1.0, v129
    v_add_f32 v130, 1.0, v130
    v_add_f32 v131, 1.0, v131
    v_add_f32 v132, 1.0, v132
    v_add_f32 v133, 1.0, v133
    v_add_f32 v134, 1.0, v134
    v_add_f32 v135, 1.0, v135
    v_rcp_f32 v128, v128
    v_rcp_f32 v129, v129
    v_rcp_f32 v130, v130
    v_rcp_f32 v131, v131
    v_rcp_f32 v132, v132
    v_rcp_f32 v133, v133
    v_rcp_f32 v134, v134
    v_rcp_f32 v135, v135
    v_fmac_f32 v8, v56, v128
    v_fmac_f32 v9, v57, v129
    v_fmac_f32 v10, v58, v130
    v_fmac_f32 v11, v59, v131
    v_fmac_f32 v12, v60, v132
    v_fmac_f32 v13, v61, v133
    v_fmac_f32 v14, v62, v134
    v_fmac_f32 v15, v63, v135
    s_cmp_le_u32 s52, 1
    s_cbranch_scc1 K2S_LASTU2
    s_waitcnt lgkmcnt(0)
    v_mfma_f32_32x32x16_bf16 v[48:63], v[112:115], v[124:127], v[64:79]
    s_cmp_gt_u32 s52, 3
    s_cselect_b32 s53, 0xff, -1
    s_sub_u32 s52, s52, 1
    v_exp_f32 v128, v32
    v_exp_f32 v129, v33
    s_mov_b64 exec, s[40:41]
    ds_read_b64 v[112:113], v145 offset:13888
    s_mov_b64 exec, s[42:43]
    ds_read_b64 v[114:115], v145 offset:13888
    s_mov_b64 exec, -1
    v_exp_f32 v130, v34
    v_exp_f32 v131, v35
    s_waitcnt vmcnt(2)
    v_mfma_f32_32x32x16_bf16 v[48:63], v[104:107], v[116:119], v[48:63]
    v_exp_f32 v132, v36
    v_exp_f32 v133, v37
    v_exp_f32 v134, v38
    v_exp_f32 v135, v39
    v_add_f32 v128, 1.0, v128
    v_add_f32 v129, 1.0, v129
    v_add_f32 v130, 1.0, v130
    v_add_f32 v131, 1.0, v131
    v_add_f32 v132, 1.0, v132
    v_add_f32 v133, 1.0, v133
    v_add_f32 v134, 1.0, v134
    v_add_f32 v135, 1.0, v135
    v_rcp_f32 v128, v128
    v_rcp_f32 v129, v129
    v_rcp_f32 v130, v130
    v_rcp_f32 v131, v131
    v_rcp_f32 v132, v132
    v_rcp_f32 v133, v133
    v_rcp_f32 v134, v134
    v_rcp_f32 v135, v135
    v_fmac_f32 v0, v32, v128
    v_fmac_f32 v1, v33, v129
    v_fmac_f32 v2, v34, v130
    v_fmac_f32 v3, v35, v131
    v_fmac_f32 v4, v36, v132
    v_fmac_f32 v5, v37, v133
    v_fmac_f32 v6, v38, v134
    v_fmac_f32 v7, v39, v135
    v_mfma_f32_32x32x16_bf16 v[48:63], v[108:111], v[120:123], v[48:63]
    v_exp_f32 v128, v40
    v_exp_f32 v129, v41
    v_exp_f32 v130, v42
    v_exp_f32 v131, v43
    v_bfi_b32 v137, s53, v141, v137
    buffer_load_dwordx4 v[88:91], v137, s[16:19], 0 offen
    buffer_load_dwordx4 v[92:95], v137, s[16:19], 0 offen offset:128
    v_exp_f32 v132, v44
    v_exp_f32 v133, v45
    v_exp_f32 v134, v46
    v_exp_f32 v135, v47
    v_add_f32 v128, 1.0, v128
    v_add_f32 v129, 1.0, v129
    v_add_f32 v130, 1.0, v130
    v_add_f32 v131, 1.0, v131
    v_add_f32 v132, 1.0, v132
    v_add_f32 v133, 1.0, v133
    v_add_f32 v134, 1.0, v134
    v_add_f32 v135, 1.0, v135
    v_rcp_f32 v128, v128
    v_rcp_f32 v129, v129
    v_rcp_f32 v130, v130
    v_rcp_f32 v131, v131
    v_rcp_f32 v132, v132
    v_rcp_f32 v133, v133
    v_rcp_f32 v134, v134
    v_rcp_f32 v135, v135
    v_fmac_f32 v8, v40, v128
    v_fmac_f32 v9, v41, v129
    v_fmac_f32 v10, v42, v130
    v_fmac_f32 v11, v43, v131
    v_fmac_f32 v12, v44, v132
    v_fmac_f32 v13, v45, v133
    v_fmac_f32 v14, v46, v134
    v_fmac_f32 v15, v47, v135
    s_cmp_le_u32 s52, 1
    s_cbranch_scc1 K2S_LASTU3
    s_waitcnt lgkmcnt(0)
    v_mfma_f32_32x32x16_bf16 v[32:47], v[112:115], v[124:127], v[64:79]
    s_cmp_gt_u32 s52, 3
    s_cselect_b32 s53, 0xff, -1
    s_sub_u32 s52, s52, 1
    v_exp_f32 v128, v48
    v_exp_f32 v129, v49
    s_mov_b64 exec, s[40:41]
    ds_read_b64 v[112:113], v145 offset:13896
    s_mov_b64 exec, s[42:43]
    ds_read_b64 v[114:115], v145 offset:13896
    s_mov_b64 exec, -1
    v_exp_f32 v130, v50
    v_exp_f32 v131, v51
    s_waitcnt vmcnt(2)
    v_mfma_f32_32x32x16_bf16 v[32:47], v[80:83], v[116:119], v[32:47]
    v_exp_f32 v132, v52
    v_exp_f32 v133, v53
    v_exp_f32 v134, v54
    v_exp_f32 v135, v55
    v_add_f32 v128, 1.0, v128
    v_add_f32 v129, 1.0, v129
    v_add_f32 v130, 1.0, v130
    v_add_f32 v131, 1.0, v131
    v_add_f32 v132, 1.0, v132
    v_add_f32 v133, 1.0, v133
    v_add_f32 v134, 1.0, v134
    v_add_f32 v135, 1.0, v135
    v_rcp_f32 v128, v128
    v_rcp_f32 v129, v129
    v_rcp_f32 v130, v130
    v_rcp_f32 v131, v131
    v_rcp_f32 v132, v132
    v_rcp_f32 v133, v133
    v_rcp_f32 v134, v134
    v_rcp_f32 v135, v135
    v_fmac_f32 v0, v48, v128
    v_fmac_f32 v1, v49, v129
    v_fmac_f32 v2, v50, v130
    v_fmac_f32 v3, v51, v131
    v_fmac_f32 v4, v52, v132
    v_fmac_f32 v5, v53, v133
    v_fmac_f32 v6, v54, v134
    v_fmac_f32 v7, v55, v135
    v_mfma_f32_32x32x16_bf16 v[32:47], v[84:87], v[120:123], v[32:47]
    v_exp_f32 v128, v56
    v_exp_f32 v129, v57
    v_exp_f32 v130, v58
    v_exp_f32 v131, v59
    v_bfi_b32 v138, s53, v142, v138
    buffer_load_dwordx4 v[96:99], v138, s[16:19], 0 offen
    buffer_load_dwordx4 v[100:103], v138, s[16:19], 0 offen offset:128
    v_exp_f32 v132, v60
    v_exp_f32 v133, v61
    v_exp_f32 v134, v62
    v_exp_f32 v135, v63
    v_add_f32 v128, 1.0, v128
    v_add_f32 v129, 1.0, v129
    v_add_f32 v130, 1.0, v130
    v_add_f32 v131, 1.0, v131
    v_add_f32 v132, 1.0, v132
    v_add_f32 v133, 1.0, v133
    v_add_f32 v134, 1.0, v134
    v_add_f32 v135, 1.0, v135
    v_rcp_f32 v128, v128
    v_rcp_f32 v129, v129
    v_rcp_f32 v130, v130
    v_rcp_f32 v131, v131
    v_rcp_f32 v132, v132
    v_rcp_f32 v133, v133
    v_rcp_f32 v134, v134
    v_rcp_f32 v135, v135
    v_fmac_f32 v8, v56, v128
    v_fmac_f32 v9, v57, v129
    v_fmac_f32 v10, v58, v130
    v_fmac_f32 v11, v59, v131
    v_fmac_f32 v12, v60, v132
    v_fmac_f32 v13, v61, v133
    v_fmac_f32 v14, v62, v134
    v_fmac_f32 v15, v63, v135
    s_cmp_le_u32 s52, 1
    s_cbranch_scc1 K2S_LASTU0
    s_waitcnt lgkmcnt(0)
    v_mfma_f32_32x32x16_bf16 v[48:63], v[112:115], v[124:127], v[64:79]
    s_cmp_gt_u32 s52, 3
    s_cselect_b32 s53, 0xff, -1
    s_sub_u32 s52, s52, 1
    v_exp_f32 v128, v32
    v_exp_f32 v129, v33
    s_mov_b64 exec, s[40:41]
    ds_read_b64 v[112:113], v145 offset:13904
    s_mov_b64 exec, s[42:43]
    ds_read_b64 v[114:115], v145 offset:13904
    s_mov_b64 exec, -1
    v_exp_f32 v130, v34
    v_exp_f32 v131, v35
    s_waitcnt vmcnt(2)
    v_mfma_f32_32x32x16_bf16 v[48:63], v[88:91], v[116:119], v[48:63]
    v_exp_f32 v132, v36
    v_exp_f32 v133, v37
    v_exp_f32 v134, v38
    v_exp_f32 v135, v39
    v_add_f32 v128, 1.0, v128
    v_add_f32 v129, 1.0, v129
    v_add_f32 v130, 1.0, v130
    v_add_f32 v131, 1.0, v131
    v_add_f32 v132, 1.0, v132
    v_add_f32 v133, 1.0, v133
    v_add_f32 v134, 1.0, v134
    v_add_f32 v135, 1.0, v135
    v_rcp_f32 v128, v128
    v_rcp_f32 v129, v129
    v_rcp_f32 v130, v130
    v_rcp_f32 v131, v131
    v_rcp_f32 v132, v132
    v_rcp_f32 v133, v133
    v_rcp_f32 v134, v134
    v_rcp_f32 v135, v135
    v_fmac_f32 v0, v32, v128
    v_fmac_f32 v1, v33, v129
    v_fmac_f32 v2, v34, v130
    v_fmac_f32 v3, v35, v131
    v_fmac_f32 v4, v36, v132
    v_fmac_f32 v5, v37, v133
    v_fmac_f32 v6, v38, v134
    v_fmac_f32 v7, v39, v135
    v_mfma_f32_32x32x16_bf16 v[48:63], v[92:95], v[120:123], v[48:63]
    v_exp_f32 v128, v40
    v_exp_f32 v129, v41
    v_exp_f32 v130, v42
    v_exp_f32 v131, v43
    v_bfi_b32 v139, s53, v143, v139
    buffer_load_dwordx4 v[104:107], v139, s[16:19], 0 offen
    buffer_load_dwordx4 v[108:111], v139, s[16:19], 0 offen offset:128
    ds_read_b128 v[136:139], v144 offset:544
    v_exp_f32 v132, v44
    v_exp_f32 v133, v45
    v_exp_f32 v134, v46
    v_exp_f32 v135, v47
    v_add_f32 v128, 1.0, v128
    v_add_f32 v129, 1.0, v129
    v_add_f32 v130, 1.0, v130
    v_add_f32 v131, 1.0, v131
    v_add_f32 v132, 1.0, v132
    v_add_f32 v133, 1.0, v133
    v_add_f32 v134, 1.0, v134
    v_add_f32 v135, 1.0, v135
    v_rcp_f32 v128, v128
    v_rcp_f32 v129, v129
    v_rcp_f32 v130, v130
    v_rcp_f32 v131, v131
    v_rcp_f32 v132, v132
    v_rcp_f32 v133, v133
    v_rcp_f32 v134, v134
    v_rcp_f32 v135, v135
    v_fmac_f32 v8, v40, v128
    v_fmac_f32 v9, v41, v129
    v_fmac_f32 v10, v42, v130
    v_fmac_f32 v11, v43, v131
    v_fmac_f32 v12, v44, v132
    v_fmac_f32 v13, v45, v133
    v_fmac_f32 v14, v46, v134
    v_fmac_f32 v15, v47, v135
    v_add_u32 v144, 16, v144
    v_add_u32 v145, 32, v145
    s_branch K2S_LOOP
K2S_LASTF:
    buffer_load_dwordx4 v[104:107], v143, s[16:19], 0 offen
    buffer_load_dwordx4 v[108:111], v143, s[16:19], 0 offen offset:128
    buffer_load_dwordx4 v[80:83], v140, s[16:19], 0 offen
    buffer_load_dwordx4 v[84:87], v140, s[16:19], 0 offen offset:128
    buffer_load_dwordx4 v[152:155], v151, s[16:19], s59 offen offset:0
    buffer_load_dwordx4 v[156:159], v151, s[16:19], s59 offen offset:1024
    buffer_load_dwordx4 v[160:163], v151, s[16:19], s59 offen offset:2048
    buffer_load_dwordx4 v[164:167], v151, s[16:19], s59 offen offset:3072
    buffer_load_dwordx4 v[64:67], v151, s[16:19], s55 offen offset:0
    buffer_load_dwordx4 v[68:71], v151, s[16:19], s55 offen offset:1024
    buffer_load_dwordx4 v[72:75], v151, s[16:19], s55 offen offset:2048
    buffer_load_dwordx4 v[76:79], v151, s[16:19], s55 offen offset:3072
    v_exp_f32 v128, v0
    v_exp_f32 v129, v1
    v_exp_f32 v130, v2
    v_exp_f32 v131, v3
    v_exp_f32 v132, v4
    v_exp_f32 v133, v5
    v_exp_f32 v134, v6
    v_exp_f32 v135, v7
    v_add_f32 v128, 1.0, v128
    v_add_f32 v129, 1.0, v129
    v_add_f32 v130, 1.0, v130
    v_add_f32 v131, 1.0, v131
    v_add_f32 v132, 1.0, v132
    v_add_f32 v133, 1.0, v133
    v_add_f32 v134, 1.0, v134
    v_add_f32 v135, 1.0, v135
    v_rcp_f32 v128, v128
    v_rcp_f32 v129, v129
    v_rcp_f32 v130, v130
    v_rcp_f32 v131, v131
    v_rcp_f32 v132, v132
    v_rcp_f32 v133, v133
    v_rcp_f32 v134, v134
    v_rcp_f32 v135, v135
    v_mul_f32 v0, v0, v128
    v_mul_f32 v1, v1, v129
    v_mul_f32 v2, v2, v130
    v_mul_f32 v3, v3, v131
    v_mul_f32 v4, v4, v132
    v_mul_f32 v5, v5, v133
    v_mul_f32 v6, v6, v134
    v_mul_f32 v7, v7, v135
    v_mov_b32 v16, 1.0
    v_mov_b32 v17, 1.0
    v_mov_b32 v18, 1.0
    v_mov_b32 v19, 1.0
    v_mov_b32 v20, 1.0
    v_mov_b32 v21, 1.0
    v_mov_b32 v22, 1.0
    v_mov_b32 v23, 1.0
    v_exp_f32 v128, v8
    v_exp_f32 v129, v9
    v_exp_f32 v130, v10
    v_exp_f32 v131, v11
    v_exp_f32 v132, v12
    v_exp_f32 v133, v13
    v_exp_f32 v134, v14
    v_exp_f32 v135, v15
    v_add_f32 v128, 1.0, v128
    v_add_f32 v129, 1.0, v129
    v_add_f32 v130, 1.0, v130
    v_add_f32 v131, 1.0, v131
    v_add_f32 v132, 1.0, v132
    v_add_f32 v133, 1.0, v133
    v_add_f32 v134, 1.0, v134
    v_add_f32 v135, 1.0, v135
    v_rcp_f32 v128, v128
    v_rcp_f32 v129, v129
    v_rcp_f32 v130, v130
    v_rcp_f32 v131, v131
    v_rcp_f32 v132, v132
    v_rcp_f32 v133, v133
    v_rcp_f32 v134, v134
    v_rcp_f32 v135, v135
    v_mul_f32 v8, v8, v128
    v_mul_f32 v9, v9, v129
    v_mul_f32 v10, v10, v130
    v_mul_f32 v11, v11, v131
    v_mul_f32 v12, v12, v132
    v_mul_f32 v13, v13, v133
    v_mul_f32 v14, v14, v134
    v_mul_f32 v15, v15, v135
    v_mov_b32 v24, 1.0
    v_mov_b32 v25, 1.0
    v_mov_b32 v26, 1.0
    v_mov_b32 v27, 1.0
    v_mov_b32 v28, 1.0
    v_mov_b32 v29, 1.0
    v_mov_b32 v30, 1.0
    v_mov_b32 v31, 1.0
    s_branch K2_FLUSH
K2S_LASTU3:
    buffer_load_dwordx4 v[96:99], v142, s[16:19], 0 offen
    buffer_load_dwordx4 v[100:103], v142, s[16:19], 0 offen offset:128
    buffer_load_dwordx4 v[104:107], v143, s[16:19], 0 offen
    buffer_load_dwordx4 v[108:111], v143, s[16:19], 0 offen offset:128
    s_branch K2S_LAST1
K2S_LASTU1:
    buffer_load_dwordx4 v[80:83], v140, s[16:19], 0 offen
    buffer_load_dwordx4 v[84:87], v140, s[16:19], 0 offen offset:128
    buffer_load_dwordx4 v[88:91], v141, s[16:19], 0 offen
    buffer_load_dwordx4 v[92:95], v141, s[16:19], 0 offen offset:128
K2S_LAST1:
    buffer_load_dwordx4 v[152:155], v151, s[16:19], s59 offen offset:0
    buffer_load_dwordx4 v[156:159], v151, s[16:19], s59 offen offset:1024
    buffer_load_dwordx4 v[160:163], v151, s[16:19], s59 offen offset:2048
    buffer_load_dwordx4 v[164:167], v151, s[16:19], s59 offen offset:3072
    buffer_load_dwordx4 v[64:67], v151, s[16:19], s55 offen offset:0
    buffer_load_dwordx4 v[68:71], v151, s[16:19], s55 offen offset:1024
    buffer_load_dwordx4 v[72:75], v151, s[16:19], s55 offen offset:2048
    buffer_load_dwordx4 v[76:79], v151, s[16:19], s55 offen offset:3072
    v_exp_f32 v128, v48
    v_exp_f32 v129, v49
    v_exp_f32 v130, v50
    v_exp_f32 v131, v51
    v_exp_f32 v132, v52
    v_exp_f32 v133, v53
    v_exp_f32 v134, v54
    v_exp_f32 v135, v55
    v_add_f32 v128, 1.0, v128
    v_add_f32 v129, 1.0, v129
    v_add_f32 v130, 1.0, v130
    v_add_f32 v131, 1.0, v131
    v_add_f32 v132, 1.0, v132
    v_add_f32 v133, 1.0, v133
    v_add_f32 v134, 1.0, v134
    v_add_f32 v135, 1.0, v135
    v_rcp_f32 v128, v128
    v_rcp_f32 v129, v129
    v_rcp_f32 v130, v130
    v_rcp_f32 v131, v131
    v_rcp_f32 v132, v132
    v_rcp_f32 v133, v133
    v_rcp_f32 v134, v134
    v_rcp_f32 v135, v135
    v_fmac_f32 v0, v48, v128
    v_fmac_f32 v1, v49, v129
    v_fmac_f32 v2, v50, v130
    v_fmac_f32 v3, v51, v131
    v_fmac_f32 v4, v52, v132
    v_fmac_f32 v5, v53, v133
    v_fmac_f32 v6, v54, v134
    v_fmac_f32 v7, v55, v135
    v_exp_f32 v128, v56
    v_exp_f32 v129, v57
    v_exp_f32 v130, v58
    v_exp_f32 v131, v59
    v_exp_f32 v132, v60
    v_exp_f32 v133, v61
    v_exp_f32 v134, v62
    v_exp_f32 v135, v63
    v_add_f32 v128, 1.0, v128
    v_add_f32 v129, 1.0, v129
    v_add_f32 v130, 1.0, v130
    v_add_f32 v131, 1.0, v131
    v_add_f32 v132, 1.0, v132
    v_add_f32 v133, 1.0, v133
    v_add_f32 v134, 1.0, v134
    v_add_f32 v135, 1.0, v135
    v_rcp_f32 v128, v128
    v_rcp_f32 v129, v129
    v_rcp_f32 v130, v130
    v_rcp_f32 v131, v131
    v_rcp_f32 v132, v132
    v_rcp_f32 v133, v133
    v_rcp_f32 v134, v134
    v_rcp_f32 v135, v135
    v_fmac_f32 v8, v56, v128
    v_fmac_f32 v9, v57, v129
    v_fmac_f32 v10, v58, v130
    v_fmac_f32 v11, v59, v131
    v_fmac_f32 v12, v60, v132
    v_fmac_f32 v13, v61, v133
    v_fmac_f32 v14, v62, v134
    v_fmac_f32 v15, v63, v135
    s_branch K2_FLUSH
K2S_LASTU2:
    buffer_load_dwordx4 v[88:91], v141, s[16:19], 0 offen
    buffer_load_dwordx4 v[92:95], v141, s[16:19], 0 offen offset:128
    buffer_load_dwordx4 v[96:99], v142, s[16:19], 0 offen
    buffer_load_dwordx4 v[100:103], v142, s[16:19], 0 offen offset:128
    s_branch K2S_LAST0
K2S_LASTU0:
    buffer_load_dwordx4 v[104:107], v143, s[16:19], 0 offen
    buffer_load_dwordx4 v[108:111], v143, s[16:19], 0 offen offset:128
    buffer_load_dwordx4 v[80:83], v140, s[16:19], 0 offen
    buffer_load_dwordx4 v[84:87], v140, s[16:19], 0 offen offset:128
K2S_LAST0:
    buffer_load_dwordx4 v[152:155], v151, s[16:19], s59 offen offset:0
    buffer_load_dwordx4 v[156:159], v151, s[16:19], s59 offen offset:1024
    buffer_load_dwordx4 v[160:163], v151, s[16:19], s59 offen offset:2048
    buffer_load_dwordx4 v[164:167], v151, s[16:19], s59 offen offset:3072
    buffer_load_dwordx4 v[64:67], v151, s[16:19], s55 offen offset:0
    buffer_load_dwordx4 v[68:71], v151, s[16:19], s55 offen offset:1024
    buffer_load_dwordx4 v[72:75], v151, s[16:19], s55 offen offset:2048
    buffer_load_dwordx4 v[76:79], v151, s[16:19], s55 offen offset:3072
    v_exp_f32 v128, v32
    v_exp_f32 v129, v33
    v_exp_f32 v130, v34
    v_exp_f32 v131, v35
    v_exp_f32 v132, v36
    v_exp_f32 v133, v37
    v_exp_f32 v134, v38
    v_exp_f32 v135, v39
    v_add_f32 v128, 1.0, v128
    v_add_f32 v129, 1.0, v129
    v_add_f32 v130, 1.0, v130
    v_add_f32 v131, 1.0, v131
    v_add_f32 v132, 1.0, v132
    v_add_f32 v133, 1.0, v133
    v_add_f32 v134, 1.0, v134
    v_add_f32 v135, 1.0, v135
    v_rcp_f32 v128, v128
    v_rcp_f32 v129, v129
    v_rcp_f32 v130, v130
    v_rcp_f32 v131, v131
    v_rcp_f32 v132, v132
    v_rcp_f32 v133, v133
    v_rcp_f32 v134, v134
    v_rcp_f32 v135, v135
    v_fmac_f32 v0, v32, v128
    v_fmac_f32 v1, v33, v129
    v_fmac_f32 v2, v34, v130
    v_fmac_f32 v3, v35, v131
    v_fmac_f32 v4, v36, v132
    v_fmac_f32 v5, v37, v133
    v_fmac_f32 v6, v38, v134
    v_fmac_f32 v7, v39, v135
    v_exp_f32 v128, v40
    v_exp_f32 v129, v41
    v_exp_f32 v130, v42
    v_exp_f32 v131, v43
    v_exp_f32 v132, v44
    v_exp_f32 v133, v45
    v_exp_f32 v134, v46
    v_exp_f32 v135, v47
    v_add_f32 v128, 1.0, v128
    v_add_f32 v129, 1.0, v129
    v_add_f32 v130, 1.0, v130
    v_add_f32 v131, 1.0, v131
    v_add_f32 v132, 1.0, v132
    v_add_f32 v133, 1.0, v133
    v_add_f32 v134, 1.0, v134
    v_add_f32 v135, 1.0, v135
    v_rcp_f32 v128, v128
    v_rcp_f32 v129, v129
    v_rcp_f32 v130, v130
    v_rcp_f32 v131, v131
    v_rcp_f32 v132, v132
    v_rcp_f32 v133, v133
    v_rcp_f32 v134, v134
    v_rcp_f32 v135, v135
    v_fmac_f32 v8, v40, v128
    v_fmac_f32 v9, v41, v129
    v_fmac_f32 v10, v42, v130
    v_fmac_f32 v11, v43, v131
    v_fmac_f32 v12, v44, v132
    v_fmac_f32 v13, v45, v133
    v_fmac_f32 v14, v46, v134
    v_fmac_f32 v15, v47, v135
    s_branch K2_FLUSH
K2_OVM:
    s_mov_b64 exec, vcc
    v_mov_b32 v47, 0x7f000000
    ds_write_b32 v112, v47 offset:240
    s_mov_b64 exec, s[24:25]
    s_cbranch_execz K2_OVX
    v_lshlrev_b32 v47, 1, v41
    s_mov_b32 s47, 6537216
    buffer_load_dwordx4 v[8:11], v47, s[16:19], s47 offen offset:0
    buffer_load_dwordx4 v[12:15], v47, s[16:19], s47 offen offset:16
    buffer_load_dwordx4 v[16:19], v47, s[16:19], s47 offen offset:32
    buffer_load_dwordx4 v[20:23], v47, s[16:19], s47 offen offset:48
    s_mov_b64 exec, -1
    v_cmp_gt_u32 s[24:25], s51, v0
    v_cmp_gt_u32 s[26:27], s51, v1
    v_cmp_gt_u32 s[28:29], s51, v2
    v_cmp_gt_u32 s[30:31], s51, v3
    v_cmp_gt_u32 s[32:33], s51, v4
    v_cmp_gt_u32 s[34:35], s51, v5
    v_cmp_gt_u32 s[36:37], s51, v6
    v_cmp_gt_u32 s[38:39], s51, v7
    v_and_b32 v24, 0xfc, v0
    v_and_b32 v25, 0xfc, v1
    v_and_b32 v26, 0xfc, v2
    v_and_b32 v27, 0xfc, v3
    v_and_b32 v28, 0xfc, v4
    v_and_b32 v29, 0xfc, v5
    v_and_b32 v30, 0xfc, v6
    v_and_b32 v31, 0xfc, v7
    s_mov_b64 exec, s[24:25]
    ds_add_rtn_u32 v32, v24, v46 offset:0
    s_mov_b64 exec, s[26:27]
    ds_add_rtn_u32 v33, v25, v46 offset:0
    s_mov_b64 exec, s[28:29]
    ds_add_rtn_u32 v34, v26, v46 offset:0
    s_mov_b64 exec, s[30:31]
    ds_add_rtn_u32 v35, v27, v46 offset:0
    s_mov_b64 exec, s[32:33]
    ds_add_rtn_u32 v36, v28, v46 offset:0
    s_mov_b64 exec, s[34:35]
    ds_add_rtn_u32 v37, v29, v46 offset:0
    s_mov_b64 exec, s[36:37]
    ds_add_rtn_u32 v38, v30, v46 offset:0
    s_mov_b64 exec, s[38:39]
    ds_add_rtn_u32 v39, v31, v46 offset:0
    s_mov_b64 exec, -1
    s_mov_b32 s10, 1
K2_OVX:
    s_mov_b64 exec, -1
    s_branch K2_B1
K2_OVER:
    s_cmp_lg_u32 s45, 0
    s_cbranch_scc1 K2_RK2
    s_mov_b32 s45, 1
    s_mov_b32 s60, 0
    s_mov_b32 s61, 0
    v_lshlrev_b32 v40, 4, v147
    v_add_u32 v40, 76544, v40
    ds_write_b128 v40, v[112:115] offset:0
    ds_write_b128 v40, v[112:115] offset:12288
    ds_write_b128 v40, v[112:115] offset:24576
    s_waitcnt vmcnt(0) lgkmcnt(0)
    s_barrier
    s_branch K2_PASS
K2_FBI:
    s_load_dwordx2 s[24:25], s[0:1], 8
    s_load_dwordx2 s[28:29], s[0:1], 16
    s_load_dwordx2 s[32:33], s[0:1], 24
    s_mov_b32 s26, 3200000
    s_mov_b32 s30, 1600000
    s_mov_b32 s34, 1600000
    s_mov_b32 s27, 0x00020000
    s_mov_b32 s31, 0x00020000
    s_mov_b32 s35, 0x00020000
    s_mul_i32 s36, s3, 49
    s_mov_b32 s37, 68
    s_waitcnt lgkmcnt(0) vmcnt(0)
    s_barrier
K2_FBB:
    v_add_u32 v36, s60, v147
    v_lshlrev_b32 v37, 4, v36
    v_lshlrev_b32 v38, 5, v36
    buffer_load_dwordx4 v[0:3], v37, s[32:35], 0 offen
    buffer_load_dwordx4 v[4:7], v37, s[28:31], 0 offen
    buffer_load_dwordx4 v[8:11], v38, s[24:27], 0 offen
    buffer_load_dwordx4 v[12:15], v38, s[24:27], 0 offen offset:16
    s_mov_b32 s47, 100000
    v_cmp_gt_u32 s[38:39], s47, v36
    s_waitcnt vmcnt(0)
    v_subrev_u32 v0, s36, v0
    v_subrev_u32 v1, s36, v1
    v_subrev_u32 v2, s36, v2
    v_subrev_u32 v3, s36, v3
    s_cmp_lg_u32 s61, 0
    s_cbranch_scc1 K2_FBT
    v_cmp_gt_u32 vcc, 49, v0
    s_and_b64 s[62:63], vcc, s[38:39]
    v_cmp_gt_u32 vcc, 49, v1
    s_and_b64 s[64:65], vcc, s[38:39]
    v_cmp_gt_u32 vcc, 49, v2
    s_and_b64 s[66:67], vcc, s[38:39]
    v_cmp_gt_u32 vcc, 49, v3
    s_and_b64 s[68:69], vcc, s[38:39]
K2_FBT:
    v_lshlrev_b32 v0, 2, v0
    v_and_b32 v0, 0xfc, v0
    v_lshl_add_u32 v4, v4, 8, v0
    v_mov_b32 v16, 0
    s_mov_b64 exec, s[62:63]
    ds_add_rtn_u32 v16, v0, v46 offset:0
    s_waitcnt lgkmcnt(0)
    v_cmp_gt_u32 vcc, s51, v16
    s_mov_b64 exec, -1
    v_and_b32 v16, 0xfc, v16
    v_mad_u32_u24 v16, v0, s37, v16
    v_lshlrev_b32 v17, 1, v16
    s_andn2_b64 s[62:63], s[62:63], vcc
    s_mov_b64 exec, vcc
    ds_write_b32 v16, v4 offset:512
    ds_write_b64 v17, v[8:9] offset:13856
    s_mov_b64 exec, -1
    v_lshlrev_b32 v1, 2, v1
    v_and_b32 v1, 0xfc, v1
    v_lshl_add_u32 v5, v5, 8, v1
    v_mov_b32 v16, 0
    s_mov_b64 exec, s[64:65]
    ds_add_rtn_u32 v16, v1, v46 offset:0
    s_waitcnt lgkmcnt(0)
    v_cmp_gt_u32 vcc, s51, v16
    s_mov_b64 exec, -1
    v_and_b32 v16, 0xfc, v16
    v_mad_u32_u24 v16, v1, s37, v16
    v_lshlrev_b32 v17, 1, v16
    s_andn2_b64 s[64:65], s[64:65], vcc
    s_mov_b64 exec, vcc
    ds_write_b32 v16, v5 offset:512
    ds_write_b64 v17, v[10:11] offset:13856
    s_mov_b64 exec, -1
    v_lshlrev_b32 v2, 2, v2
    v_and_b32 v2, 0xfc, v2
    v_lshl_add_u32 v6, v6, 8, v2
    v_mov_b32 v16, 0
    s_mov_b64 exec, s[66:67]
    ds_add_rtn_u32 v16, v2, v46 offset:0
    s_waitcnt lgkmcnt(0)
    v_cmp_gt_u32 vcc, s51, v16
    s_mov_b64 exec, -1
    v_and_b32 v16, 0xfc, v16
    v_mad_u32_u24 v16, v2, s37, v16
    v_lshlrev_b32 v17, 1, v16
    s_andn2_b64 s[66:67], s[66:67], vcc
    s_mov_b64 exec, vcc
    ds_write_b32 v16, v6 offset:512
    ds_write_b64 v17, v[12:13] offset:13856
    s_mov_b64 exec, -1
    v_lshlrev_b32 v3, 2, v3
    v_and_b32 v3, 0xfc, v3
    v_lshl_add_u32 v7, v7, 8, v3
    v_mov_b32 v16, 0
    s_mov_b64 exec, s[68:69]
    ds_add_rtn_u32 v16, v3, v46 offset:0
    s_waitcnt lgkmcnt(0)
    v_cmp_gt_u32 vcc, s51, v16
    s_mov_b64 exec, -1
    v_and_b32 v16, 0xfc, v16
    v_mad_u32_u24 v16, v3, s37, v16
    v_lshlrev_b32 v17, 1, v16
    s_andn2_b64 s[68:69], s[68:69], vcc
    s_mov_b64 exec, vcc
    ds_write_b32 v16, v7 offset:512
    ds_write_b64 v17, v[14:15] offset:13856
    s_mov_b64 exec, -1
    s_waitcnt lgkmcnt(0)
    s_barrier
    ds_read_b32 v47, v150 offset:0
    s_mov_b32 s47, 0x410000
    s_waitcnt lgkmcnt(0)
    v_cmp_le_u32 vcc, s47, v47
    s_barrier
    s_mov_b32 s61, 1
    s_cbranch_vccnz K2_B1
    s_mov_b32 s61, 0
    s_add_u32 s60, s60, 768
    s_cmp_lt_u32 s60, 100000
    s_cbranch_scc1 K2_FBB
    s_branch K2_B1
K2_FBN:
    s_cmp_lt_u32 s60, 100000
    s_cbranch_scc0 K2_FBC
    s_waitcnt vmcnt(0)
    s_branch K2_PASS
K2_FBC:
    v_add_u32 v0, 0, v147
    v_min_u32 v0, 1567, v0
    v_lshrrev_b32 v1, 5, v0
    v_lshlrev_b32 v1, 4, v1
    v_lshl_add_u32 v1, v0, 3, v1
    v_lshlrev_b32 v2, 1, v1
    v_add_u32 v2, 76544, v2
    ds_read_b128 v[4:7], v2
    s_waitcnt lgkmcnt(0)
    v_cvt_pk_bf16_f32 v4, v4, v5
    v_cvt_pk_bf16_f32 v5, v6, v7
    ds_write_b64 v1, v[4:5] offset:42528
    v_add_u32 v0, 768, v147
    v_min_u32 v0, 1567, v0
    v_lshrrev_b32 v1, 5, v0
    v_lshlrev_b32 v1, 4, v1
    v_lshl_add_u32 v1, v0, 3, v1
    v_lshlrev_b32 v2, 1, v1
    v_add_u32 v2, 76544, v2
    ds_read_b128 v[4:7], v2
    s_waitcnt lgkmcnt(0)
    v_cvt_pk_bf16_f32 v4, v4, v5
    v_cvt_pk_bf16_f32 v5, v6, v7
    ds_write_b64 v1, v[4:5] offset:42528
    v_add_u32 v0, 1536, v147
    v_min_u32 v0, 1567, v0
    v_lshrrev_b32 v1, 5, v0
    v_lshlrev_b32 v1, 4, v1
    v_lshl_add_u32 v1, v0, 3, v1
    v_lshlrev_b32 v2, 1, v1
    v_add_u32 v2, 76544, v2
    ds_read_b128 v[4:7], v2
    s_waitcnt lgkmcnt(0)
    v_cvt_pk_bf16_f32 v4, v4, v5
    v_cvt_pk_bf16_f32 v5, v6, v7
    ds_write_b64 v1, v[4:5] offset:42528
    s_waitcnt lgkmcnt(0)
    s_barrier
    s_branch K2_FIN
K2_TEND:
.section .rodata,"a"
.p2align 6
.amdhsa_kernel mpnn_part_kernel
  .amdhsa_next_free_vgpr 128
  .amdhsa_next_free_sgpr 96
  .amdhsa_accum_offset 128
  .amdhsa_group_segment_fixed_size 0
  .amdhsa_kernarg_size 72
  .amdhsa_user_sgpr_count 2
  .amdhsa_user_sgpr_kernarg_segment_ptr 1
  .amdhsa_system_sgpr_workgroup_id_x 1
.end_amdhsa_kernel
.p2align 6
.amdhsa_kernel gather_scatter__mpnn_edge_mlp__graph_kernel
  .amdhsa_next_free_vgpr 168
  .amdhsa_next_free_sgpr 96
  .amdhsa_accum_offset 168
  .amdhsa_group_segment_fixed_size 0
  .amdhsa_kernarg_size 72
  .amdhsa_user_sgpr_count 2
  .amdhsa_user_sgpr_kernarg_segment_ptr 1
  .amdhsa_system_sgpr_workgroup_id_x 1
.end_amdhsa_kernel
```
